```python
import torch

def _softmax(x, axis=-1):
    return torch.softmax(x, dim=axis)

def _gelu(x):
    return torch.nn.functional.gelu(x, approximate='tanh')

def _silu(x):
    return torch.nn.functional.silu(x)

def _sigmoid(x):
    return torch.sigmoid(x)

def _layernorm(x, axis=-1, eps=1e-05):
    m = x.mean(dim=axis, keepdim=True)
    v = x.var(dim=axis, keepdim=True, unbiased=False)
    return (x - m) / torch.sqrt(v + eps)

def _scatter_add(tgt, idx, src, axis=0):
    return tgt.clone().index_add_(axis, idx, src)

def _segment_sum(src, seg, n):
    out = torch.zeros((n,) + src.shape[1:], dtype=src.dtype)
    return out.index_add_(0, seg, src)

def _pad(x, pw):
    flat = tuple((v for pair in reversed(pw) for v in pair))
    return torch.nn.functional.pad(x, flat)
kernel_name = 'gather_scatter__molecular_angular_painn__graph'

def setup_inputs():

    _w = lambda a: (lambda t: t.to(torch.bfloat16) if t.is_floating_point() else t)(torch.as_tensor(a))
    N, deg, D = (10000, 16, 256)
    n_rbf = max(4, 4)
    E = N * deg
    cutoff = 5.0
    freqs = (torch.arange(1, n_rbf + 1) * torch.pi / cutoff).to(float)
    return {'sv': _w((lambda *s: torch.randn(*s, dtype=torch.bfloat16) * 0.4)(N, 4, D) * 0.3), 'pos': _w((lambda *s: torch.randn(*s, dtype=torch.bfloat16) * 3.2)(N, 3) * 1.2), 'src': _w((lambda lo, hi, *s: torch.randint(lo, hi, s))(0, N, E).to(torch.int64)), 'dst': _w((lambda lo, hi, *s: torch.randint(lo, hi, s))(0, N, E).to(torch.int64)), 'freqs': _w(freqs), 'w_phi1': _w((lambda *s: torch.randn(*s, dtype=torch.bfloat16) * 3.2)(D, D) / D ** 0.5), 'w_phi2': _w((lambda *s: torch.randn(*s, dtype=torch.bfloat16) * 3.2)(D, 3 * D) / D ** 0.5), 'w_rbf': _w((lambda *s: torch.randn(*s, dtype=torch.bfloat16) * 3.2)(n_rbf, 3 * D) / n_rbf ** 0.5)}

def reference(sv, pos, src, dst, freqs, w_phi1, w_phi2, w_rbf):
    N, _, D = sv.shape
    E = src.shape[0]
    PI, cutoff = (3.141592653589793, 5.0)
    s, v = (sv[:, 0, :].clone(), sv[:, 1:, :].clone())
    r_vec = pos[src] - pos[dst]
    d = torch.sqrt((r_vec * r_vec).sum(-1) + 1e-08)
    r_hat = r_vec / d[:, None]
    rbf = torch.sin(d[:, None] * freqs[None, :]) / d[:, None]
    fcut = 0.5 * (torch.cos(PI * d / cutoff) + 1.0)
    fcut = torch.where(d < cutoff, fcut, 0.0 * d)
    Wf = rbf @ w_rbf * fcut[:, None]
    phi = (_silu(s @ w_phi1) @ w_phi2)[src]
    m = phi * Wf
    m_s, m_vv, m_vr = (m[:, :D].clone(), m[:, D:2 * D].clone(), m[:, 2 * D:].clone())
    ds = _segment_sum(m_s, dst, N)
    dv_e = m_vv[:, None, :] * v[src] + m_vr[:, None, :] * r_hat[:, :, None]
    dv = _segment_sum(dv_e.reshape(E, 3 * D), dst, N).reshape(N, 3, D)
    return sv + torch.concatenate([ds[:, None, :], dv], axis=1)
```

```asm
; @launch kernel=k_phi_kernel grid=(250,1,1) block=(512,1,1) lds=87104
; @launch kernel=k_edge_kernel grid=(250,1,1) block=(1024,1,1) lds=134144
.amdgcn_target "amdgcn-amd-amdhsa--gfx950"
.text
.globl k_phi_kernel
.p2align 8
.type k_phi_kernel,@function
k_phi_kernel:
    s_cmp_ge_u32 s2, 250
    s_cbranch_scc1 K1_END
    s_load_dwordx8 s[4:11], s[0:1], 0
    s_load_dwordx8 s[12:19], s[0:1], 32
    s_load_dwordx2 s[20:21], s[0:1], 80
    v_lshrrev_b32 v2, 6, v0
    v_and_b32 v1, 63, v0
    s_lshr_b32 s65, s2, 1
    v_readfirstlane_b32 s64, v2
    s_and_b32 s66, s2, 1
    s_mul_i32 s65, s65, 80
    s_mov_b32 s68, 0x05040100
    s_mov_b32 s69, 0x07060302
    v_lshrrev_b32 v7, 5, v0
    v_and_b32 v8, 31, v0
    v_lshlrev_b32 v8, 4, v8
    v_add_u32 v9, s65, v7
    v_lshl_add_u32 v9, v9, 11, v8
    v_mul_u32_u24 v7, 544, v7
    v_add_u32 v7, v7, v8
    s_waitcnt lgkmcnt(0)
    s_mov_b32 s24, s4
    s_and_b32 s25, s5, 0xffff
    s_mov_b32 s26, 20480000
    s_mov_b32 s27, 0x20000
    s_mov_b32 s67, 0
    buffer_load_dwordx4 v[12:15], v9, s[24:27], s67 offen
    s_mov_b32 s67, 32768
    buffer_load_dwordx4 v[16:19], v9, s[24:27], s67 offen
    s_mov_b32 s67, 65536
    buffer_load_dwordx4 v[20:23], v9, s[24:27], s67 offen
    s_mov_b32 s67, 98304
    buffer_load_dwordx4 v[24:27], v9, s[24:27], s67 offen
    s_mov_b32 s67, 131072
    buffer_load_dwordx4 v[28:31], v9, s[24:27], s67 offen
    v_mov_b32 v10, 0
    v_mov_b32 v11, 0
    v_mov_b32 v8, 87040
    ds_write_b64 v8, v[10:11]
    s_barrier
    s_cmp_ge_u32 s64, 4
    s_cbranch_scc1 K1_PREP
    s_setprio 3
    s_mov_b32 s28, s14
    s_and_b32 s29, s15, 0xffff
    s_mov_b32 s30, 131072
    s_mov_b32 s31, 0x20000
    s_mov_b32 s32, s16
    s_and_b32 s33, s17, 0xffff
    s_mov_b32 s34, 393216
    s_mov_b32 s35, 0x20000
    s_add_u32 s36, s20, 0
    s_addc_u32 s37, s21, 0
    s_and_b32 s37, s37, 0xffff
    s_mov_b32 s38, 15360000
    s_mov_b32 s39, 0x20000
    v_and_b32 v10, 15, v1
    v_lshrrev_b32 v11, 4, v1
    s_lshl_b32 s70, s64, 7
    v_lshlrev_b32 v2, 12, v11
    v_lshl_add_u32 v2, v10, 3, v2
    v_add_u32 v2, s70, v2
    s_mov_b32 s67, 0
    buffer_load_dwordx2 v[60:61], v2, s[28:31], s67 offen offset:0
    buffer_load_dwordx2 v[62:63], v2, s[28:31], s67 offen offset:512
    buffer_load_dwordx2 v[64:65], v2, s[28:31], s67 offen offset:1024
    buffer_load_dwordx2 v[66:67], v2, s[28:31], s67 offen offset:1536
    buffer_load_dwordx2 v[68:69], v2, s[28:31], s67 offen offset:2048
    buffer_load_dwordx2 v[70:71], v2, s[28:31], s67 offen offset:2560
    buffer_load_dwordx2 v[72:73], v2, s[28:31], s67 offen offset:3072
    buffer_load_dwordx2 v[74:75], v2, s[28:31], s67 offen offset:3584
    s_mov_b32 s67, 16384
    buffer_load_dwordx2 v[76:77], v2, s[28:31], s67 offen offset:0
    buffer_load_dwordx2 v[78:79], v2, s[28:31], s67 offen offset:512
    buffer_load_dwordx2 v[80:81], v2, s[28:31], s67 offen offset:1024
    buffer_load_dwordx2 v[82:83], v2, s[28:31], s67 offen offset:1536
    buffer_load_dwordx2 v[84:85], v2, s[28:31], s67 offen offset:2048
    buffer_load_dwordx2 v[86:87], v2, s[28:31], s67 offen offset:2560
    buffer_load_dwordx2 v[88:89], v2, s[28:31], s67 offen offset:3072
    buffer_load_dwordx2 v[90:91], v2, s[28:31], s67 offen offset:3584
    s_mov_b32 s67, 32768
    buffer_load_dwordx2 v[92:93], v2, s[28:31], s67 offen offset:0
    buffer_load_dwordx2 v[94:95], v2, s[28:31], s67 offen offset:512
    buffer_load_dwordx2 v[96:97], v2, s[28:31], s67 offen offset:1024
    buffer_load_dwordx2 v[98:99], v2, s[28:31], s67 offen offset:1536
    buffer_load_dwordx2 v[100:101], v2, s[28:31], s67 offen offset:2048
    buffer_load_dwordx2 v[102:103], v2, s[28:31], s67 offen offset:2560
    buffer_load_dwordx2 v[104:105], v2, s[28:31], s67 offen offset:3072
    buffer_load_dwordx2 v[106:107], v2, s[28:31], s67 offen offset:3584
    s_mov_b32 s67, 49152
    buffer_load_dwordx2 v[108:109], v2, s[28:31], s67 offen offset:0
    buffer_load_dwordx2 v[110:111], v2, s[28:31], s67 offen offset:512
    buffer_load_dwordx2 v[112:113], v2, s[28:31], s67 offen offset:1024
    buffer_load_dwordx2 v[114:115], v2, s[28:31], s67 offen offset:1536
    buffer_load_dwordx2 v[116:117], v2, s[28:31], s67 offen offset:2048
    buffer_load_dwordx2 v[118:119], v2, s[28:31], s67 offen offset:2560
    buffer_load_dwordx2 v[120:121], v2, s[28:31], s67 offen offset:3072
    buffer_load_dwordx2 v[122:123], v2, s[28:31], s67 offen offset:3584
    s_mul_i32 s70, s66, 768
    s_mul_i32 s71, s64, 192
    s_add_u32 s70, s70, s71
    v_mul_u32_u24 v3, 12, v10
    v_add_u32 v3, s70, v3
    v_mul_u32_u24 v6, 6144, v11
    v_add_u32 v6, v6, v3
    s_mul_i32 s71, s65, 1536
    v_add_u32 v6, s71, v6
    v_mul_u32_u24 v8, 12288, v11
    v_add_u32 v3, v8, v3
    v_mul_u32_u24 v4, 544, v10
    v_lshl_add_u32 v4, v11, 4, v4
    s_lshl_b32 s70, s64, 7
    s_add_u32 s70, s70, 43520
    v_mul_u32_u24 v5, 2176, v11
    v_lshl_add_u32 v5, v10, 3, v5
    v_add_u32 v5, s70, v5
    s_waitcnt vmcnt(32)
    ds_write_b128 v7, v[12:15] offset:0
    ds_write_b128 v7, v[16:19] offset:8704
    ds_write_b128 v7, v[20:23] offset:17408
    ds_write_b128 v7, v[24:27] offset:26112
    ds_write_b128 v7, v[28:31] offset:34816
    s_waitcnt lgkmcnt(0)
    s_barrier
    ds_read_b128 v[12:15], v4 offset:0
    ds_read_b128 v[16:19], v4 offset:8704
    ds_read_b128 v[20:23], v4 offset:17408
    ds_read_b128 v[24:27], v4 offset:26112
    ds_read_b128 v[28:31], v4 offset:34816
    s_waitcnt vmcnt(24)
    v_perm_b32 v52, v62, v60, s68
    v_perm_b32 v53, v66, v64, s68
    v_perm_b32 v54, v70, v68, s68
    v_perm_b32 v55, v74, v72, s68
    s_nop 1
    ds_read_b128 v[32:35], v4 offset:64
    ds_read_b128 v[36:39], v4 offset:8768
    ds_read_b128 v[40:43], v4 offset:17472
    ds_read_b128 v[44:47], v4 offset:26176
    ds_read_b128 v[48:51], v4 offset:34880
    s_waitcnt lgkmcnt(5)
    v_mfma_f32_16x16x32_bf16 v[124:127], v[12:15], v[52:55], 0
    v_perm_b32 v56, v62, v60, s69
    v_perm_b32 v57, v66, v64, s69
    v_mfma_f32_16x16x32_bf16 v[140:143], v[16:19], v[52:55], 0
    v_perm_b32 v58, v70, v68, s69
    v_perm_b32 v59, v74, v72, s69
    v_mfma_f32_16x16x32_bf16 v[156:159], v[20:23], v[52:55], 0
    v_mfma_f32_16x16x32_bf16 v[172:175], v[24:27], v[52:55], 0
    v_mfma_f32_16x16x32_bf16 v[188:191], v[28:31], v[52:55], 0
    v_mfma_f32_16x16x32_bf16 v[128:131], v[12:15], v[56:59], 0
    v_perm_b32 v52, v63, v61, s68
    v_perm_b32 v53, v67, v65, s68
    v_mfma_f32_16x16x32_bf16 v[144:147], v[16:19], v[56:59], 0
    v_perm_b32 v54, v71, v69, s68
    v_perm_b32 v55, v75, v73, s68
    v_mfma_f32_16x16x32_bf16 v[160:163], v[20:23], v[56:59], 0
    v_mfma_f32_16x16x32_bf16 v[176:179], v[24:27], v[56:59], 0
    v_mfma_f32_16x16x32_bf16 v[192:195], v[28:31], v[56:59], 0
    v_mfma_f32_16x16x32_bf16 v[132:135], v[12:15], v[52:55], 0
    v_perm_b32 v56, v63, v61, s69
    v_perm_b32 v57, v67, v65, s69
    v_mfma_f32_16x16x32_bf16 v[148:151], v[16:19], v[52:55], 0
    v_perm_b32 v58, v71, v69, s69
    v_perm_b32 v59, v75, v73, s69
    v_mfma_f32_16x16x32_bf16 v[164:167], v[20:23], v[52:55], 0
    v_mfma_f32_16x16x32_bf16 v[180:183], v[24:27], v[52:55], 0
    v_mfma_f32_16x16x32_bf16 v[196:199], v[28:31], v[52:55], 0
    v_mfma_f32_16x16x32_bf16 v[136:139], v[12:15], v[56:59], 0
    s_waitcnt vmcnt(16)
    v_perm_b32 v52, v78, v76, s68
    v_perm_b32 v53, v82, v80, s68
    v_mfma_f32_16x16x32_bf16 v[152:155], v[16:19], v[56:59], 0
    v_perm_b32 v54, v86, v84, s68
    v_perm_b32 v55, v90, v88, s68
    v_mfma_f32_16x16x32_bf16 v[168:171], v[20:23], v[56:59], 0
    s_mov_b32 s67, 65536
    buffer_load_dwordx2 v[60:61], v2, s[28:31], s67 offen offset:0
    buffer_load_dwordx2 v[62:63], v2, s[28:31], s67 offen offset:512
    buffer_load_dwordx2 v[64:65], v2, s[28:31], s67 offen offset:1024
    buffer_load_dwordx2 v[66:67], v2, s[28:31], s67 offen offset:1536
    buffer_load_dwordx2 v[68:69], v2, s[28:31], s67 offen offset:2048
    buffer_load_dwordx2 v[70:71], v2, s[28:31], s67 offen offset:2560
    buffer_load_dwordx2 v[72:73], v2, s[28:31], s67 offen offset:3072
    buffer_load_dwordx2 v[74:75], v2, s[28:31], s67 offen offset:3584
    v_mfma_f32_16x16x32_bf16 v[184:187], v[24:27], v[56:59], 0
    v_mfma_f32_16x16x32_bf16 v[200:203], v[28:31], v[56:59], 0
    ds_read_b128 v[12:15], v4 offset:128
    ds_read_b128 v[16:19], v4 offset:8832
    ds_read_b128 v[20:23], v4 offset:17536
    ds_read_b128 v[24:27], v4 offset:26240
    ds_read_b128 v[28:31], v4 offset:34944
    s_waitcnt lgkmcnt(5)
    v_mfma_f32_16x16x32_bf16 v[124:127], v[32:35], v[52:55], v[124:127]
    v_perm_b32 v56, v78, v76, s69
    v_perm_b32 v57, v82, v80, s69
    v_mfma_f32_16x16x32_bf16 v[140:143], v[36:39], v[52:55], v[140:143]
    v_perm_b32 v58, v86, v84, s69
    v_perm_b32 v59, v90, v88, s69
    v_mfma_f32_16x16x32_bf16 v[156:159], v[40:43], v[52:55], v[156:159]
    v_mfma_f32_16x16x32_bf16 v[172:175], v[44:47], v[52:55], v[172:175]
    v_mfma_f32_16x16x32_bf16 v[188:191], v[48:51], v[52:55], v[188:191]
    v_mfma_f32_16x16x32_bf16 v[128:131], v[32:35], v[56:59], v[128:131]
    v_perm_b32 v52, v79, v77, s68
    v_perm_b32 v53, v83, v81, s68
    v_mfma_f32_16x16x32_bf16 v[144:147], v[36:39], v[56:59], v[144:147]
    v_perm_b32 v54, v87, v85, s68
    v_perm_b32 v55, v91, v89, s68
    v_mfma_f32_16x16x32_bf16 v[160:163], v[40:43], v[56:59], v[160:163]
    v_mfma_f32_16x16x32_bf16 v[176:179], v[44:47], v[56:59], v[176:179]
    v_mfma_f32_16x16x32_bf16 v[192:195], v[48:51], v[56:59], v[192:195]
    v_mfma_f32_16x16x32_bf16 v[132:135], v[32:35], v[52:55], v[132:135]
    v_perm_b32 v56, v79, v77, s69
    v_perm_b32 v57, v83, v81, s69
    v_mfma_f32_16x16x32_bf16 v[148:151], v[36:39], v[52:55], v[148:151]
    v_perm_b32 v58, v87, v85, s69
    v_perm_b32 v59, v91, v89, s69
    v_mfma_f32_16x16x32_bf16 v[164:167], v[40:43], v[52:55], v[164:167]
    v_mfma_f32_16x16x32_bf16 v[180:183], v[44:47], v[52:55], v[180:183]
    v_mfma_f32_16x16x32_bf16 v[196:199], v[48:51], v[52:55], v[196:199]
    v_mfma_f32_16x16x32_bf16 v[136:139], v[32:35], v[56:59], v[136:139]
    s_waitcnt vmcnt(16)
    v_perm_b32 v52, v94, v92, s68
    v_perm_b32 v53, v98, v96, s68
    v_mfma_f32_16x16x32_bf16 v[152:155], v[36:39], v[56:59], v[152:155]
    v_perm_b32 v54, v102, v100, s68
    v_perm_b32 v55, v106, v104, s68
    v_mfma_f32_16x16x32_bf16 v[168:171], v[40:43], v[56:59], v[168:171]
    s_mov_b32 s67, 81920
    buffer_load_dwordx2 v[76:77], v2, s[28:31], s67 offen offset:0
    buffer_load_dwordx2 v[78:79], v2, s[28:31], s67 offen offset:512
    buffer_load_dwordx2 v[80:81], v2, s[28:31], s67 offen offset:1024
    buffer_load_dwordx2 v[82:83], v2, s[28:31], s67 offen offset:1536
    buffer_load_dwordx2 v[84:85], v2, s[28:31], s67 offen offset:2048
    buffer_load_dwordx2 v[86:87], v2, s[28:31], s67 offen offset:2560
    buffer_load_dwordx2 v[88:89], v2, s[28:31], s67 offen offset:3072
    buffer_load_dwordx2 v[90:91], v2, s[28:31], s67 offen offset:3584
    v_mfma_f32_16x16x32_bf16 v[184:187], v[44:47], v[56:59], v[184:187]
    v_mfma_f32_16x16x32_bf16 v[200:203], v[48:51], v[56:59], v[200:203]
    ds_read_b128 v[32:35], v4 offset:192
    ds_read_b128 v[36:39], v4 offset:8896
    ds_read_b128 v[40:43], v4 offset:17600
    ds_read_b128 v[44:47], v4 offset:26304
    ds_read_b128 v[48:51], v4 offset:35008
    s_waitcnt lgkmcnt(5)
    v_mfma_f32_16x16x32_bf16 v[124:127], v[12:15], v[52:55], v[124:127]
    v_perm_b32 v56, v94, v92, s69
    v_perm_b32 v57, v98, v96, s69
    v_mfma_f32_16x16x32_bf16 v[140:143], v[16:19], v[52:55], v[140:143]
    v_perm_b32 v58, v102, v100, s69
    v_perm_b32 v59, v106, v104, s69
    v_mfma_f32_16x16x32_bf16 v[156:159], v[20:23], v[52:55], v[156:159]
    v_mfma_f32_16x16x32_bf16 v[172:175], v[24:27], v[52:55], v[172:175]
    v_mfma_f32_16x16x32_bf16 v[188:191], v[28:31], v[52:55], v[188:191]
    v_mfma_f32_16x16x32_bf16 v[128:131], v[12:15], v[56:59], v[128:131]
    v_perm_b32 v52, v95, v93, s68
    v_perm_b32 v53, v99, v97, s68
    v_mfma_f32_16x16x32_bf16 v[144:147], v[16:19], v[56:59], v[144:147]
    v_perm_b32 v54, v103, v101, s68
    v_perm_b32 v55, v107, v105, s68
    v_mfma_f32_16x16x32_bf16 v[160:163], v[20:23], v[56:59], v[160:163]
    v_mfma_f32_16x16x32_bf16 v[176:179], v[24:27], v[56:59], v[176:179]
    v_mfma_f32_16x16x32_bf16 v[192:195], v[28:31], v[56:59], v[192:195]
    v_mfma_f32_16x16x32_bf16 v[132:135], v[12:15], v[52:55], v[132:135]
    v_perm_b32 v56, v95, v93, s69
    v_perm_b32 v57, v99, v97, s69
    v_mfma_f32_16x16x32_bf16 v[148:151], v[16:19], v[52:55], v[148:151]
    v_perm_b32 v58, v103, v101, s69
    v_perm_b32 v59, v107, v105, s69
    v_mfma_f32_16x16x32_bf16 v[164:167], v[20:23], v[52:55], v[164:167]
    v_mfma_f32_16x16x32_bf16 v[180:183], v[24:27], v[52:55], v[180:183]
    v_mfma_f32_16x16x32_bf16 v[196:199], v[28:31], v[52:55], v[196:199]
    v_mfma_f32_16x16x32_bf16 v[136:139], v[12:15], v[56:59], v[136:139]
    s_waitcnt vmcnt(16)
    v_perm_b32 v52, v110, v108, s68
    v_perm_b32 v53, v114, v112, s68
    v_mfma_f32_16x16x32_bf16 v[152:155], v[16:19], v[56:59], v[152:155]
    v_perm_b32 v54, v118, v116, s68
    v_perm_b32 v55, v122, v120, s68
    v_mfma_f32_16x16x32_bf16 v[168:171], v[20:23], v[56:59], v[168:171]
    s_mov_b32 s67, 98304
    buffer_load_dwordx2 v[92:93], v2, s[28:31], s67 offen offset:0
    buffer_load_dwordx2 v[94:95], v2, s[28:31], s67 offen offset:512
    buffer_load_dwordx2 v[96:97], v2, s[28:31], s67 offen offset:1024
    buffer_load_dwordx2 v[98:99], v2, s[28:31], s67 offen offset:1536
    buffer_load_dwordx2 v[100:101], v2, s[28:31], s67 offen offset:2048
    buffer_load_dwordx2 v[102:103], v2, s[28:31], s67 offen offset:2560
    buffer_load_dwordx2 v[104:105], v2, s[28:31], s67 offen offset:3072
    buffer_load_dwordx2 v[106:107], v2, s[28:31], s67 offen offset:3584
    v_mfma_f32_16x16x32_bf16 v[184:187], v[24:27], v[56:59], v[184:187]
    v_mfma_f32_16x16x32_bf16 v[200:203], v[28:31], v[56:59], v[200:203]
    ds_read_b128 v[12:15], v4 offset:256
    ds_read_b128 v[16:19], v4 offset:8960
    ds_read_b128 v[20:23], v4 offset:17664
    ds_read_b128 v[24:27], v4 offset:26368
    ds_read_b128 v[28:31], v4 offset:35072
    s_waitcnt lgkmcnt(5)
    v_mfma_f32_16x16x32_bf16 v[124:127], v[32:35], v[52:55], v[124:127]
    v_perm_b32 v56, v110, v108, s69
    v_perm_b32 v57, v114, v112, s69
    v_mfma_f32_16x16x32_bf16 v[140:143], v[36:39], v[52:55], v[140:143]
    v_perm_b32 v58, v118, v116, s69
    v_perm_b32 v59, v122, v120, s69
    v_mfma_f32_16x16x32_bf16 v[156:159], v[40:43], v[52:55], v[156:159]
    v_mfma_f32_16x16x32_bf16 v[172:175], v[44:47], v[52:55], v[172:175]
    v_mfma_f32_16x16x32_bf16 v[188:191], v[48:51], v[52:55], v[188:191]
    v_mfma_f32_16x16x32_bf16 v[128:131], v[32:35], v[56:59], v[128:131]
    v_perm_b32 v52, v111, v109, s68
    v_perm_b32 v53, v115, v113, s68
    v_mfma_f32_16x16x32_bf16 v[144:147], v[36:39], v[56:59], v[144:147]
    v_perm_b32 v54, v119, v117, s68
    v_perm_b32 v55, v123, v121, s68
    v_mfma_f32_16x16x32_bf16 v[160:163], v[40:43], v[56:59], v[160:163]
    v_mfma_f32_16x16x32_bf16 v[176:179], v[44:47], v[56:59], v[176:179]
    v_mfma_f32_16x16x32_bf16 v[192:195], v[48:51], v[56:59], v[192:195]
    v_mfma_f32_16x16x32_bf16 v[132:135], v[32:35], v[52:55], v[132:135]
    v_perm_b32 v56, v111, v109, s69
    v_perm_b32 v57, v115, v113, s69
    v_mfma_f32_16x16x32_bf16 v[148:151], v[36:39], v[52:55], v[148:151]
    v_perm_b32 v58, v119, v117, s69
    v_perm_b32 v59, v123, v121, s69
    v_mfma_f32_16x16x32_bf16 v[164:167], v[40:43], v[52:55], v[164:167]
    v_mfma_f32_16x16x32_bf16 v[180:183], v[44:47], v[52:55], v[180:183]
    v_mfma_f32_16x16x32_bf16 v[196:199], v[48:51], v[52:55], v[196:199]
    v_mfma_f32_16x16x32_bf16 v[136:139], v[32:35], v[56:59], v[136:139]
    s_waitcnt vmcnt(16)
    v_perm_b32 v52, v62, v60, s68
    v_perm_b32 v53, v66, v64, s68
    v_mfma_f32_16x16x32_bf16 v[152:155], v[36:39], v[56:59], v[152:155]
    v_perm_b32 v54, v70, v68, s68
    v_perm_b32 v55, v74, v72, s68
    v_mfma_f32_16x16x32_bf16 v[168:171], v[40:43], v[56:59], v[168:171]
    s_mov_b32 s67, 114688
    buffer_load_dwordx2 v[108:109], v2, s[28:31], s67 offen offset:0
    buffer_load_dwordx2 v[110:111], v2, s[28:31], s67 offen offset:512
    buffer_load_dwordx2 v[112:113], v2, s[28:31], s67 offen offset:1024
    buffer_load_dwordx2 v[114:115], v2, s[28:31], s67 offen offset:1536
    buffer_load_dwordx2 v[116:117], v2, s[28:31], s67 offen offset:2048
    buffer_load_dwordx2 v[118:119], v2, s[28:31], s67 offen offset:2560
    buffer_load_dwordx2 v[120:121], v2, s[28:31], s67 offen offset:3072
    buffer_load_dwordx2 v[122:123], v2, s[28:31], s67 offen offset:3584
    v_mfma_f32_16x16x32_bf16 v[184:187], v[44:47], v[56:59], v[184:187]
    v_mfma_f32_16x16x32_bf16 v[200:203], v[48:51], v[56:59], v[200:203]
    ds_read_b128 v[32:35], v4 offset:320
    ds_read_b128 v[36:39], v4 offset:9024
    ds_read_b128 v[40:43], v4 offset:17728
    ds_read_b128 v[44:47], v4 offset:26432
    ds_read_b128 v[48:51], v4 offset:35136
    s_waitcnt lgkmcnt(5)
    v_mfma_f32_16x16x32_bf16 v[124:127], v[12:15], v[52:55], v[124:127]
    v_perm_b32 v56, v62, v60, s69
    v_perm_b32 v57, v66, v64, s69
    v_mfma_f32_16x16x32_bf16 v[140:143], v[16:19], v[52:55], v[140:143]
    v_perm_b32 v58, v70, v68, s69
    v_perm_b32 v59, v74, v72, s69
    v_mfma_f32_16x16x32_bf16 v[156:159], v[20:23], v[52:55], v[156:159]
    v_mfma_f32_16x16x32_bf16 v[172:175], v[24:27], v[52:55], v[172:175]
    v_mfma_f32_16x16x32_bf16 v[188:191], v[28:31], v[52:55], v[188:191]
    v_mfma_f32_16x16x32_bf16 v[128:131], v[12:15], v[56:59], v[128:131]
    v_perm_b32 v52, v63, v61, s68
    v_perm_b32 v53, v67, v65, s68
    v_mfma_f32_16x16x32_bf16 v[144:147], v[16:19], v[56:59], v[144:147]
    v_perm_b32 v54, v71, v69, s68
    v_perm_b32 v55, v75, v73, s68
    v_mfma_f32_16x16x32_bf16 v[160:163], v[20:23], v[56:59], v[160:163]
    v_mfma_f32_16x16x32_bf16 v[176:179], v[24:27], v[56:59], v[176:179]
    v_mfma_f32_16x16x32_bf16 v[192:195], v[28:31], v[56:59], v[192:195]
    v_mfma_f32_16x16x32_bf16 v[132:135], v[12:15], v[52:55], v[132:135]
    v_perm_b32 v56, v63, v61, s69
    v_perm_b32 v57, v67, v65, s69
    v_mfma_f32_16x16x32_bf16 v[148:151], v[16:19], v[52:55], v[148:151]
    v_perm_b32 v58, v71, v69, s69
    v_perm_b32 v59, v75, v73, s69
    v_mfma_f32_16x16x32_bf16 v[164:167], v[20:23], v[52:55], v[164:167]
    v_mfma_f32_16x16x32_bf16 v[180:183], v[24:27], v[52:55], v[180:183]
    v_mfma_f32_16x16x32_bf16 v[196:199], v[28:31], v[52:55], v[196:199]
    v_mfma_f32_16x16x32_bf16 v[136:139], v[12:15], v[56:59], v[136:139]
    s_waitcnt vmcnt(16)
    v_perm_b32 v52, v78, v76, s68
    v_perm_b32 v53, v82, v80, s68
    v_mfma_f32_16x16x32_bf16 v[152:155], v[16:19], v[56:59], v[152:155]
    v_perm_b32 v54, v86, v84, s68
    v_perm_b32 v55, v90, v88, s68
    v_mfma_f32_16x16x32_bf16 v[168:171], v[20:23], v[56:59], v[168:171]
    v_mfma_f32_16x16x32_bf16 v[184:187], v[24:27], v[56:59], v[184:187]
    v_mfma_f32_16x16x32_bf16 v[200:203], v[28:31], v[56:59], v[200:203]
    ds_read_b128 v[12:15], v4 offset:384
    ds_read_b128 v[16:19], v4 offset:9088
    ds_read_b128 v[20:23], v4 offset:17792
    ds_read_b128 v[24:27], v4 offset:26496
    ds_read_b128 v[28:31], v4 offset:35200
    s_waitcnt lgkmcnt(5)
    v_mfma_f32_16x16x32_bf16 v[124:127], v[32:35], v[52:55], v[124:127]
    v_perm_b32 v56, v78, v76, s69
    v_perm_b32 v57, v82, v80, s69
    v_mfma_f32_16x16x32_bf16 v[140:143], v[36:39], v[52:55], v[140:143]
    v_perm_b32 v58, v86, v84, s69
    v_perm_b32 v59, v90, v88, s69
    v_mfma_f32_16x16x32_bf16 v[156:159], v[40:43], v[52:55], v[156:159]
    v_mfma_f32_16x16x32_bf16 v[172:175], v[44:47], v[52:55], v[172:175]
    v_mfma_f32_16x16x32_bf16 v[188:191], v[48:51], v[52:55], v[188:191]
    v_mfma_f32_16x16x32_bf16 v[128:131], v[32:35], v[56:59], v[128:131]
    v_perm_b32 v52, v79, v77, s68
    v_perm_b32 v53, v83, v81, s68
    v_mfma_f32_16x16x32_bf16 v[144:147], v[36:39], v[56:59], v[144:147]
    v_perm_b32 v54, v87, v85, s68
    v_perm_b32 v55, v91, v89, s68
    v_mfma_f32_16x16x32_bf16 v[160:163], v[40:43], v[56:59], v[160:163]
    v_mfma_f32_16x16x32_bf16 v[176:179], v[44:47], v[56:59], v[176:179]
    v_mfma_f32_16x16x32_bf16 v[192:195], v[48:51], v[56:59], v[192:195]
    v_mfma_f32_16x16x32_bf16 v[132:135], v[32:35], v[52:55], v[132:135]
    v_perm_b32 v56, v79, v77, s69
    v_perm_b32 v57, v83, v81, s69
    v_mfma_f32_16x16x32_bf16 v[148:151], v[36:39], v[52:55], v[148:151]
    v_perm_b32 v58, v87, v85, s69
    v_perm_b32 v59, v91, v89, s69
    v_mfma_f32_16x16x32_bf16 v[164:167], v[40:43], v[52:55], v[164:167]
    v_mfma_f32_16x16x32_bf16 v[180:183], v[44:47], v[52:55], v[180:183]
    v_mfma_f32_16x16x32_bf16 v[196:199], v[48:51], v[52:55], v[196:199]
    v_mfma_f32_16x16x32_bf16 v[136:139], v[32:35], v[56:59], v[136:139]
    s_waitcnt vmcnt(8)
    v_perm_b32 v52, v94, v92, s68
    v_perm_b32 v53, v98, v96, s68
    v_mfma_f32_16x16x32_bf16 v[152:155], v[36:39], v[56:59], v[152:155]
    v_perm_b32 v54, v102, v100, s68
    v_perm_b32 v55, v106, v104, s68
    v_mfma_f32_16x16x32_bf16 v[168:171], v[40:43], v[56:59], v[168:171]
    v_mfma_f32_16x16x32_bf16 v[184:187], v[44:47], v[56:59], v[184:187]
    v_mfma_f32_16x16x32_bf16 v[200:203], v[48:51], v[56:59], v[200:203]
    ds_read_b128 v[32:35], v4 offset:448
    ds_read_b128 v[36:39], v4 offset:9152
    ds_read_b128 v[40:43], v4 offset:17856
    ds_read_b128 v[44:47], v4 offset:26560
    ds_read_b128 v[48:51], v4 offset:35264
    s_waitcnt lgkmcnt(5)
    v_mfma_f32_16x16x32_bf16 v[124:127], v[12:15], v[52:55], v[124:127]
    v_perm_b32 v56, v94, v92, s69
    v_perm_b32 v57, v98, v96, s69
    v_mfma_f32_16x16x32_bf16 v[140:143], v[16:19], v[52:55], v[140:143]
    v_perm_b32 v58, v102, v100, s69
    v_perm_b32 v59, v106, v104, s69
    v_mfma_f32_16x16x32_bf16 v[156:159], v[20:23], v[52:55], v[156:159]
    v_mfma_f32_16x16x32_bf16 v[172:175], v[24:27], v[52:55], v[172:175]
    v_mfma_f32_16x16x32_bf16 v[188:191], v[28:31], v[52:55], v[188:191]
    v_mfma_f32_16x16x32_bf16 v[128:131], v[12:15], v[56:59], v[128:131]
    v_perm_b32 v52, v95, v93, s68
    v_perm_b32 v53, v99, v97, s68
    v_mfma_f32_16x16x32_bf16 v[144:147], v[16:19], v[56:59], v[144:147]
    v_perm_b32 v54, v103, v101, s68
    v_perm_b32 v55, v107, v105, s68
    v_mfma_f32_16x16x32_bf16 v[160:163], v[20:23], v[56:59], v[160:163]
    v_mfma_f32_16x16x32_bf16 v[176:179], v[24:27], v[56:59], v[176:179]
    v_mfma_f32_16x16x32_bf16 v[192:195], v[28:31], v[56:59], v[192:195]
    v_mfma_f32_16x16x32_bf16 v[132:135], v[12:15], v[52:55], v[132:135]
    v_perm_b32 v56, v95, v93, s69
    v_perm_b32 v57, v99, v97, s69
    v_mfma_f32_16x16x32_bf16 v[148:151], v[16:19], v[52:55], v[148:151]
    v_perm_b32 v58, v103, v101, s69
    v_perm_b32 v59, v107, v105, s69
    v_mfma_f32_16x16x32_bf16 v[164:167], v[20:23], v[52:55], v[164:167]
    v_mfma_f32_16x16x32_bf16 v[180:183], v[24:27], v[52:55], v[180:183]
    v_mfma_f32_16x16x32_bf16 v[196:199], v[28:31], v[52:55], v[196:199]
    v_mfma_f32_16x16x32_bf16 v[136:139], v[12:15], v[56:59], v[136:139]
    s_waitcnt vmcnt(0)
    v_perm_b32 v52, v110, v108, s68
    v_perm_b32 v53, v114, v112, s68
    v_mfma_f32_16x16x32_bf16 v[152:155], v[16:19], v[56:59], v[152:155]
    v_perm_b32 v54, v118, v116, s68
    v_perm_b32 v55, v122, v120, s68
    v_mfma_f32_16x16x32_bf16 v[168:171], v[20:23], v[56:59], v[168:171]
    v_mfma_f32_16x16x32_bf16 v[184:187], v[24:27], v[56:59], v[184:187]
    v_mfma_f32_16x16x32_bf16 v[200:203], v[28:31], v[56:59], v[200:203]
    s_waitcnt lgkmcnt(0)
    v_mfma_f32_16x16x32_bf16 v[124:127], v[32:35], v[52:55], v[124:127]
    v_perm_b32 v56, v110, v108, s69
    v_perm_b32 v57, v114, v112, s69
    v_mfma_f32_16x16x32_bf16 v[140:143], v[36:39], v[52:55], v[140:143]
    v_perm_b32 v58, v118, v116, s69
    v_perm_b32 v59, v122, v120, s69
    v_mfma_f32_16x16x32_bf16 v[156:159], v[40:43], v[52:55], v[156:159]
    v_mfma_f32_16x16x32_bf16 v[172:175], v[44:47], v[52:55], v[172:175]
    v_mfma_f32_16x16x32_bf16 v[188:191], v[48:51], v[52:55], v[188:191]
    v_mfma_f32_16x16x32_bf16 v[128:131], v[32:35], v[56:59], v[128:131]
    v_perm_b32 v52, v111, v109, s68
    v_perm_b32 v53, v115, v113, s68
    v_mfma_f32_16x16x32_bf16 v[144:147], v[36:39], v[56:59], v[144:147]
    v_perm_b32 v54, v119, v117, s68
    v_perm_b32 v55, v123, v121, s68
    v_mfma_f32_16x16x32_bf16 v[160:163], v[40:43], v[56:59], v[160:163]
    v_mfma_f32_16x16x32_bf16 v[176:179], v[44:47], v[56:59], v[176:179]
    v_mfma_f32_16x16x32_bf16 v[192:195], v[48:51], v[56:59], v[192:195]
    v_mfma_f32_16x16x32_bf16 v[132:135], v[32:35], v[52:55], v[132:135]
    v_perm_b32 v56, v111, v109, s69
    v_perm_b32 v57, v115, v113, s69
    v_mfma_f32_16x16x32_bf16 v[148:151], v[36:39], v[52:55], v[148:151]
    v_perm_b32 v58, v119, v117, s69
    v_perm_b32 v59, v123, v121, s69
    v_mfma_f32_16x16x32_bf16 v[164:167], v[40:43], v[52:55], v[164:167]
    v_mfma_f32_16x16x32_bf16 v[180:183], v[44:47], v[52:55], v[180:183]
    v_mfma_f32_16x16x32_bf16 v[196:199], v[48:51], v[52:55], v[196:199]
    v_mfma_f32_16x16x32_bf16 v[136:139], v[32:35], v[56:59], v[136:139]
    v_mfma_f32_16x16x32_bf16 v[152:155], v[36:39], v[56:59], v[152:155]
    v_mfma_f32_16x16x32_bf16 v[168:171], v[40:43], v[56:59], v[168:171]
    v_mfma_f32_16x16x32_bf16 v[184:187], v[44:47], v[56:59], v[184:187]
    v_mfma_f32_16x16x32_bf16 v[200:203], v[48:51], v[56:59], v[200:203]
    s_mov_b32 s67, 0
    buffer_load_dwordx3 v[60:62], v3, s[32:35], s67 offen offset:0
    buffer_load_dwordx3 v[64:66], v3, s[32:35], s67 offen offset:1536
    buffer_load_dwordx3 v[68:70], v3, s[32:35], s67 offen offset:3072
    s_mov_b32 s67, 4608
    buffer_load_dwordx3 v[72:74], v3, s[32:35], s67 offen offset:0
    buffer_load_dwordx3 v[76:78], v3, s[32:35], s67 offen offset:1536
    buffer_load_dwordx3 v[80:82], v3, s[32:35], s67 offen offset:3072
    s_mov_b32 s67, 9216
    buffer_load_dwordx3 v[84:86], v3, s[32:35], s67 offen offset:0
    buffer_load_dwordx3 v[88:90], v3, s[32:35], s67 offen offset:1536
    s_mov_b32 s67, 49152
    buffer_load_dwordx3 v[92:94], v3, s[32:35], s67 offen offset:0
    buffer_load_dwordx3 v[96:98], v3, s[32:35], s67 offen offset:1536
    buffer_load_dwordx3 v[100:102], v3, s[32:35], s67 offen offset:3072
    s_mov_b32 s67, 53760
    buffer_load_dwordx3 v[104:106], v3, s[32:35], s67 offen offset:0
    buffer_load_dwordx3 v[108:110], v3, s[32:35], s67 offen offset:1536
    buffer_load_dwordx3 v[112:114], v3, s[32:35], s67 offen offset:3072
    s_mov_b32 s67, 58368
    buffer_load_dwordx3 v[116:118], v3, s[32:35], s67 offen offset:0
    buffer_load_dwordx3 v[120:122], v3, s[32:35], s67 offen offset:1536
    s_mul_i32 s70, s66, 40
    s_add_u32 s70, s70, s65
    s_lshl_b32 s70, s70, 11
    s_add_u32 s70, s70, 512
    s_lshl_b32 s71, s64, 6
    s_add_u32 s71, s71, 0
    v_add_u32 v10, s71, v1
    v_mul_u32_u24 v9, 2731, v10
    v_lshrrev_b32 v9, 16, v9
    v_mul_u32_u24 v8, 24, v9
    v_sub_u32 v10, v10, v8
    v_lshlrev_b32 v10, 6, v10
    v_lshl_add_u32 v10, v9, 11, v10
    buffer_load_dword v11, v10, s[24:27], s70 offen
    s_lshl_b32 s71, s64, 6
    s_add_u32 s71, s71, 256
    v_add_u32 v10, s71, v1
    v_mul_u32_u24 v9, 2731, v10
    v_lshrrev_b32 v9, 16, v9
    v_mul_u32_u24 v8, 24, v9
    v_sub_u32 v10, v10, v8
    v_lshlrev_b32 v10, 6, v10
    v_lshl_add_u32 v10, v9, 11, v10
    buffer_load_dword v11, v10, s[24:27], s70 offen
    s_nop 7
    s_mov_b32 s40, 0xbfb8aa3b
    s_mov_b32 s41, 0xbfb8aa3b
    s_mov_b32 s42, 1.0
    s_mov_b32 s43, 1.0
    v_pk_mul_f32 v[12:13], v[124:125], s[40:41]
    v_pk_mul_f32 v[14:15], v[128:129], s[40:41]
    v_pk_mul_f32 v[16:17], v[132:133], s[40:41]
    v_pk_mul_f32 v[18:19], v[136:137], s[40:41]
    v_exp_f32 v12, v12
    v_exp_f32 v13, v13
    v_exp_f32 v14, v14
    v_exp_f32 v15, v15
    v_exp_f32 v16, v16
    v_exp_f32 v17, v17
    v_exp_f32 v18, v18
    v_exp_f32 v19, v19
    v_pk_add_f32 v[12:13], v[12:13], s[42:43]
    v_pk_add_f32 v[14:15], v[14:15], s[42:43]
    v_pk_add_f32 v[16:17], v[16:17], s[42:43]
    v_pk_add_f32 v[18:19], v[18:19], s[42:43]
    v_rcp_f32 v12, v12
    v_rcp_f32 v13, v13
    v_rcp_f32 v14, v14
    v_rcp_f32 v15, v15
    v_rcp_f32 v16, v16
    v_rcp_f32 v17, v17
    v_rcp_f32 v18, v18
    v_rcp_f32 v19, v19
    v_pk_mul_f32 v[12:13], v[12:13], v[124:125]
    v_pk_mul_f32 v[14:15], v[14:15], v[128:129]
    v_pk_mul_f32 v[16:17], v[16:17], v[132:133]
    v_pk_mul_f32 v[18:19], v[18:19], v[136:137]
    v_cvt_pk_bf16_f32 v20, v12, v14
    v_cvt_pk_bf16_f32 v21, v16, v18
    ds_write_b64 v5, v[20:21] offset:0
    v_cvt_pk_bf16_f32 v22, v13, v15
    v_cvt_pk_bf16_f32 v23, v17, v19
    ds_write_b64 v5, v[22:23] offset:544
    v_pk_mul_f32 v[24:25], v[126:127], s[40:41]
    v_pk_mul_f32 v[26:27], v[130:131], s[40:41]
    v_pk_mul_f32 v[28:29], v[134:135], s[40:41]
    v_pk_mul_f32 v[30:31], v[138:139], s[40:41]
    v_exp_f32 v24, v24
    v_exp_f32 v25, v25
    v_exp_f32 v26, v26
    v_exp_f32 v27, v27
    v_exp_f32 v28, v28
    v_exp_f32 v29, v29
    v_exp_f32 v30, v30
    v_exp_f32 v31, v31
    v_pk_add_f32 v[24:25], v[24:25], s[42:43]
    v_pk_add_f32 v[26:27], v[26:27], s[42:43]
    v_pk_add_f32 v[28:29], v[28:29], s[42:43]
    v_pk_add_f32 v[30:31], v[30:31], s[42:43]
    v_rcp_f32 v24, v24
    v_rcp_f32 v25, v25
    v_rcp_f32 v26, v26
    v_rcp_f32 v27, v27
    v_rcp_f32 v28, v28
    v_rcp_f32 v29, v29
    v_rcp_f32 v30, v30
    v_rcp_f32 v31, v31
    v_pk_mul_f32 v[24:25], v[24:25], v[126:127]
    v_pk_mul_f32 v[26:27], v[26:27], v[130:131]
    v_pk_mul_f32 v[28:29], v[28:29], v[134:135]
    v_pk_mul_f32 v[30:31], v[30:31], v[138:139]
    v_cvt_pk_bf16_f32 v32, v24, v26
    v_cvt_pk_bf16_f32 v33, v28, v30
    ds_write_b64 v5, v[32:33] offset:1088
    v_cvt_pk_bf16_f32 v34, v25, v27
    v_cvt_pk_bf16_f32 v35, v29, v31
    ds_write_b64 v5, v[34:35] offset:1632
    v_pk_mul_f32 v[12:13], v[140:141], s[40:41]
    v_pk_mul_f32 v[14:15], v[144:145], s[40:41]
    v_pk_mul_f32 v[16:17], v[148:149], s[40:41]
    v_pk_mul_f32 v[18:19], v[152:153], s[40:41]
    v_exp_f32 v12, v12
    v_exp_f32 v13, v13
    v_exp_f32 v14, v14
    v_exp_f32 v15, v15
    v_exp_f32 v16, v16
    v_exp_f32 v17, v17
    v_exp_f32 v18, v18
    v_exp_f32 v19, v19
    v_pk_add_f32 v[12:13], v[12:13], s[42:43]
    v_pk_add_f32 v[14:15], v[14:15], s[42:43]
    v_pk_add_f32 v[16:17], v[16:17], s[42:43]
    v_pk_add_f32 v[18:19], v[18:19], s[42:43]
    v_rcp_f32 v12, v12
    v_rcp_f32 v13, v13
    v_rcp_f32 v14, v14
    v_rcp_f32 v15, v15
    v_rcp_f32 v16, v16
    v_rcp_f32 v17, v17
    v_rcp_f32 v18, v18
    v_rcp_f32 v19, v19
    v_pk_mul_f32 v[12:13], v[12:13], v[140:141]
    v_pk_mul_f32 v[14:15], v[14:15], v[144:145]
    v_pk_mul_f32 v[16:17], v[16:17], v[148:149]
    v_pk_mul_f32 v[18:19], v[18:19], v[152:153]
    v_cvt_pk_bf16_f32 v20, v12, v14
    v_cvt_pk_bf16_f32 v21, v16, v18
    ds_write_b64 v5, v[20:21] offset:8704
    v_cvt_pk_bf16_f32 v22, v13, v15
    v_cvt_pk_bf16_f32 v23, v17, v19
    ds_write_b64 v5, v[22:23] offset:9248
    v_pk_mul_f32 v[24:25], v[142:143], s[40:41]
    v_pk_mul_f32 v[26:27], v[146:147], s[40:41]
    v_pk_mul_f32 v[28:29], v[150:151], s[40:41]
    v_pk_mul_f32 v[30:31], v[154:155], s[40:41]
    v_exp_f32 v24, v24
    v_exp_f32 v25, v25
    v_exp_f32 v26, v26
    v_exp_f32 v27, v27
    v_exp_f32 v28, v28
    v_exp_f32 v29, v29
    v_exp_f32 v30, v30
    v_exp_f32 v31, v31
    v_pk_add_f32 v[24:25], v[24:25], s[42:43]
    v_pk_add_f32 v[26:27], v[26:27], s[42:43]
    v_pk_add_f32 v[28:29], v[28:29], s[42:43]
    v_pk_add_f32 v[30:31], v[30:31], s[42:43]
    v_rcp_f32 v24, v24
    v_rcp_f32 v25, v25
    v_rcp_f32 v26, v26
    v_rcp_f32 v27, v27
    v_rcp_f32 v28, v28
    v_rcp_f32 v29, v29
    v_rcp_f32 v30, v30
    v_rcp_f32 v31, v31
    v_pk_mul_f32 v[24:25], v[24:25], v[142:143]
    v_pk_mul_f32 v[26:27], v[26:27], v[146:147]
    v_pk_mul_f32 v[28:29], v[28:29], v[150:151]
    v_pk_mul_f32 v[30:31], v[30:31], v[154:155]
    v_cvt_pk_bf16_f32 v32, v24, v26
    v_cvt_pk_bf16_f32 v33, v28, v30
    ds_write_b64 v5, v[32:33] offset:9792
    v_cvt_pk_bf16_f32 v34, v25, v27
    v_cvt_pk_bf16_f32 v35, v29, v31
    ds_write_b64 v5, v[34:35] offset:10336
    v_pk_mul_f32 v[12:13], v[156:157], s[40:41]
    v_pk_mul_f32 v[14:15], v[160:161], s[40:41]
    v_pk_mul_f32 v[16:17], v[164:165], s[40:41]
    v_pk_mul_f32 v[18:19], v[168:169], s[40:41]
    v_exp_f32 v12, v12
    v_exp_f32 v13, v13
    v_exp_f32 v14, v14
    v_exp_f32 v15, v15
    v_exp_f32 v16, v16
    v_exp_f32 v17, v17
    v_exp_f32 v18, v18
    v_exp_f32 v19, v19
    v_pk_add_f32 v[12:13], v[12:13], s[42:43]
    v_pk_add_f32 v[14:15], v[14:15], s[42:43]
    v_pk_add_f32 v[16:17], v[16:17], s[42:43]
    v_pk_add_f32 v[18:19], v[18:19], s[42:43]
    v_rcp_f32 v12, v12
    v_rcp_f32 v13, v13
    v_rcp_f32 v14, v14
    v_rcp_f32 v15, v15
    v_rcp_f32 v16, v16
    v_rcp_f32 v17, v17
    v_rcp_f32 v18, v18
    v_rcp_f32 v19, v19
    v_pk_mul_f32 v[12:13], v[12:13], v[156:157]
    v_pk_mul_f32 v[14:15], v[14:15], v[160:161]
    v_pk_mul_f32 v[16:17], v[16:17], v[164:165]
    v_pk_mul_f32 v[18:19], v[18:19], v[168:169]
    v_cvt_pk_bf16_f32 v20, v12, v14
    v_cvt_pk_bf16_f32 v21, v16, v18
    ds_write_b64 v5, v[20:21] offset:17408
    v_cvt_pk_bf16_f32 v22, v13, v15
    v_cvt_pk_bf16_f32 v23, v17, v19
    ds_write_b64 v5, v[22:23] offset:17952
    v_pk_mul_f32 v[24:25], v[158:159], s[40:41]
    v_pk_mul_f32 v[26:27], v[162:163], s[40:41]
    v_pk_mul_f32 v[28:29], v[166:167], s[40:41]
    v_pk_mul_f32 v[30:31], v[170:171], s[40:41]
    v_exp_f32 v24, v24
    v_exp_f32 v25, v25
    v_exp_f32 v26, v26
    v_exp_f32 v27, v27
    v_exp_f32 v28, v28
    v_exp_f32 v29, v29
    v_exp_f32 v30, v30
    v_exp_f32 v31, v31
    v_pk_add_f32 v[24:25], v[24:25], s[42:43]
    v_pk_add_f32 v[26:27], v[26:27], s[42:43]
    v_pk_add_f32 v[28:29], v[28:29], s[42:43]
    v_pk_add_f32 v[30:31], v[30:31], s[42:43]
    v_rcp_f32 v24, v24
    v_rcp_f32 v25, v25
    v_rcp_f32 v26, v26
    v_rcp_f32 v27, v27
    v_rcp_f32 v28, v28
    v_rcp_f32 v29, v29
    v_rcp_f32 v30, v30
    v_rcp_f32 v31, v31
    v_pk_mul_f32 v[24:25], v[24:25], v[158:159]
    v_pk_mul_f32 v[26:27], v[26:27], v[162:163]
    v_pk_mul_f32 v[28:29], v[28:29], v[166:167]
    v_pk_mul_f32 v[30:31], v[30:31], v[170:171]
    v_cvt_pk_bf16_f32 v32, v24, v26
    v_cvt_pk_bf16_f32 v33, v28, v30
    ds_write_b64 v5, v[32:33] offset:18496
    v_cvt_pk_bf16_f32 v34, v25, v27
    v_cvt_pk_bf16_f32 v35, v29, v31
    ds_write_b64 v5, v[34:35] offset:19040
    v_pk_mul_f32 v[12:13], v[172:173], s[40:41]
    v_pk_mul_f32 v[14:15], v[176:177], s[40:41]
    v_pk_mul_f32 v[16:17], v[180:181], s[40:41]
    v_pk_mul_f32 v[18:19], v[184:185], s[40:41]
    v_exp_f32 v12, v12
    v_exp_f32 v13, v13
    v_exp_f32 v14, v14
    v_exp_f32 v15, v15
    v_exp_f32 v16, v16
    v_exp_f32 v17, v17
    v_exp_f32 v18, v18
    v_exp_f32 v19, v19
    v_pk_add_f32 v[12:13], v[12:13], s[42:43]
    v_pk_add_f32 v[14:15], v[14:15], s[42:43]
    v_pk_add_f32 v[16:17], v[16:17], s[42:43]
    v_pk_add_f32 v[18:19], v[18:19], s[42:43]
    v_rcp_f32 v12, v12
    v_rcp_f32 v13, v13
    v_rcp_f32 v14, v14
    v_rcp_f32 v15, v15
    v_rcp_f32 v16, v16
    v_rcp_f32 v17, v17
    v_rcp_f32 v18, v18
    v_rcp_f32 v19, v19
    v_pk_mul_f32 v[12:13], v[12:13], v[172:173]
    v_pk_mul_f32 v[14:15], v[14:15], v[176:177]
    v_pk_mul_f32 v[16:17], v[16:17], v[180:181]
    v_pk_mul_f32 v[18:19], v[18:19], v[184:185]
    v_cvt_pk_bf16_f32 v20, v12, v14
    v_cvt_pk_bf16_f32 v21, v16, v18
    ds_write_b64 v5, v[20:21] offset:26112
    v_cvt_pk_bf16_f32 v22, v13, v15
    v_cvt_pk_bf16_f32 v23, v17, v19
    ds_write_b64 v5, v[22:23] offset:26656
    v_pk_mul_f32 v[24:25], v[174:175], s[40:41]
    v_pk_mul_f32 v[26:27], v[178:179], s[40:41]
    v_pk_mul_f32 v[28:29], v[182:183], s[40:41]
    v_pk_mul_f32 v[30:31], v[186:187], s[40:41]
    v_exp_f32 v24, v24
    v_exp_f32 v25, v25
    v_exp_f32 v26, v26
    v_exp_f32 v27, v27
    v_exp_f32 v28, v28
    v_exp_f32 v29, v29
    v_exp_f32 v30, v30
    v_exp_f32 v31, v31
    v_pk_add_f32 v[24:25], v[24:25], s[42:43]
    v_pk_add_f32 v[26:27], v[26:27], s[42:43]
    v_pk_add_f32 v[28:29], v[28:29], s[42:43]
    v_pk_add_f32 v[30:31], v[30:31], s[42:43]
    v_rcp_f32 v24, v24
    v_rcp_f32 v25, v25
    v_rcp_f32 v26, v26
    v_rcp_f32 v27, v27
    v_rcp_f32 v28, v28
    v_rcp_f32 v29, v29
    v_rcp_f32 v30, v30
    v_rcp_f32 v31, v31
    v_pk_mul_f32 v[24:25], v[24:25], v[174:175]
    v_pk_mul_f32 v[26:27], v[26:27], v[178:179]
    v_pk_mul_f32 v[28:29], v[28:29], v[182:183]
    v_pk_mul_f32 v[30:31], v[30:31], v[186:187]
    v_cvt_pk_bf16_f32 v32, v24, v26
    v_cvt_pk_bf16_f32 v33, v28, v30
    ds_write_b64 v5, v[32:33] offset:27200
    v_cvt_pk_bf16_f32 v34, v25, v27
    v_cvt_pk_bf16_f32 v35, v29, v31
    ds_write_b64 v5, v[34:35] offset:27744
    v_pk_mul_f32 v[12:13], v[188:189], s[40:41]
    v_pk_mul_f32 v[14:15], v[192:193], s[40:41]
    v_pk_mul_f32 v[16:17], v[196:197], s[40:41]
    v_pk_mul_f32 v[18:19], v[200:201], s[40:41]
    v_exp_f32 v12, v12
    v_exp_f32 v13, v13
    v_exp_f32 v14, v14
    v_exp_f32 v15, v15
    v_exp_f32 v16, v16
    v_exp_f32 v17, v17
    v_exp_f32 v18, v18
    v_exp_f32 v19, v19
    v_pk_add_f32 v[12:13], v[12:13], s[42:43]
    v_pk_add_f32 v[14:15], v[14:15], s[42:43]
    v_pk_add_f32 v[16:17], v[16:17], s[42:43]
    v_pk_add_f32 v[18:19], v[18:19], s[42:43]
    v_rcp_f32 v12, v12
    v_rcp_f32 v13, v13
    v_rcp_f32 v14, v14
    v_rcp_f32 v15, v15
    v_rcp_f32 v16, v16
    v_rcp_f32 v17, v17
    v_rcp_f32 v18, v18
    v_rcp_f32 v19, v19
    v_pk_mul_f32 v[12:13], v[12:13], v[188:189]
    v_pk_mul_f32 v[14:15], v[14:15], v[192:193]
    v_pk_mul_f32 v[16:17], v[16:17], v[196:197]
    v_pk_mul_f32 v[18:19], v[18:19], v[200:201]
    v_cvt_pk_bf16_f32 v20, v12, v14
    v_cvt_pk_bf16_f32 v21, v16, v18
    ds_write_b64 v5, v[20:21] offset:34816
    v_cvt_pk_bf16_f32 v22, v13, v15
    v_cvt_pk_bf16_f32 v23, v17, v19
    ds_write_b64 v5, v[22:23] offset:35360
    v_pk_mul_f32 v[24:25], v[190:191], s[40:41]
    v_pk_mul_f32 v[26:27], v[194:195], s[40:41]
    v_pk_mul_f32 v[28:29], v[198:199], s[40:41]
    v_pk_mul_f32 v[30:31], v[202:203], s[40:41]
    v_exp_f32 v24, v24
    v_exp_f32 v25, v25
    v_exp_f32 v26, v26
    v_exp_f32 v27, v27
    v_exp_f32 v28, v28
    v_exp_f32 v29, v29
    v_exp_f32 v30, v30
    v_exp_f32 v31, v31
    v_pk_add_f32 v[24:25], v[24:25], s[42:43]
    v_pk_add_f32 v[26:27], v[26:27], s[42:43]
    v_pk_add_f32 v[28:29], v[28:29], s[42:43]
    v_pk_add_f32 v[30:31], v[30:31], s[42:43]
    v_rcp_f32 v24, v24
    v_rcp_f32 v25, v25
    v_rcp_f32 v26, v26
    v_rcp_f32 v27, v27
    v_rcp_f32 v28, v28
    v_rcp_f32 v29, v29
    v_rcp_f32 v30, v30
    v_rcp_f32 v31, v31
    v_pk_mul_f32 v[24:25], v[24:25], v[190:191]
    v_pk_mul_f32 v[26:27], v[26:27], v[194:195]
    v_pk_mul_f32 v[28:29], v[28:29], v[198:199]
    v_pk_mul_f32 v[30:31], v[30:31], v[202:203]
    v_cvt_pk_bf16_f32 v32, v24, v26
    v_cvt_pk_bf16_f32 v33, v28, v30
    ds_write_b64 v5, v[32:33] offset:35904
    v_cvt_pk_bf16_f32 v34, v25, v27
    v_cvt_pk_bf16_f32 v35, v29, v31
    ds_write_b64 v5, v[34:35] offset:36448
    s_waitcnt lgkmcnt(0)
    v_mov_b32 v8, 87040
    v_mov_b32 v9, 1
    s_mov_b64 exec, 1
    ds_add_u32 v8, v9
    s_mov_b64 exec, -1
K1_SPIN:
    ds_read_b32 v9, v8
    s_waitcnt lgkmcnt(0)
    v_readfirstlane_b32 s70, v9
    s_cmp_lt_u32 s70, 4
    s_cbranch_scc1 K1_SPIN
    v_add_u32 v4, 43520, v4
    ds_read_b128 v[12:15], v4 offset:0
    ds_read_b128 v[16:19], v4 offset:8704
    ds_read_b128 v[20:23], v4 offset:17408
    ds_read_b128 v[24:27], v4 offset:26112
    ds_read_b128 v[28:31], v4 offset:34816
    s_waitcnt vmcnt(10)
    v_perm_b32 v52, v64, v60, s68
    v_perm_b32 v53, v72, v68, s68
    v_perm_b32 v54, v80, v76, s68
    v_perm_b32 v55, v88, v84, s68
    s_nop 1
    ds_read_b128 v[32:35], v4 offset:64
    ds_read_b128 v[36:39], v4 offset:8768
    ds_read_b128 v[40:43], v4 offset:17472
    ds_read_b128 v[44:47], v4 offset:26176
    ds_read_b128 v[48:51], v4 offset:34880
    s_waitcnt lgkmcnt(5)
    v_mfma_f32_16x16x32_bf16 v[124:127], v[12:15], v[52:55], 0
    v_perm_b32 v56, v64, v60, s69
    v_perm_b32 v57, v72, v68, s69
    v_mfma_f32_16x16x32_bf16 v[148:151], v[16:19], v[52:55], 0
    v_perm_b32 v58, v80, v76, s69
    v_perm_b32 v59, v88, v84, s69
    v_mfma_f32_16x16x32_bf16 v[172:175], v[20:23], v[52:55], 0
    v_mfma_f32_16x16x32_bf16 v[196:199], v[24:27], v[52:55], 0
    v_mfma_f32_16x16x32_bf16 a[16:19], v[28:31], v[52:55], 0
    v_mfma_f32_16x16x32_bf16 v[128:131], v[12:15], v[56:59], 0
    v_perm_b32 v52, v65, v61, s68
    v_perm_b32 v53, v73, v69, s68
    v_mfma_f32_16x16x32_bf16 v[152:155], v[16:19], v[56:59], 0
    v_perm_b32 v54, v81, v77, s68
    v_perm_b32 v55, v89, v85, s68
    v_mfma_f32_16x16x32_bf16 v[176:179], v[20:23], v[56:59], 0
    v_mfma_f32_16x16x32_bf16 v[200:203], v[24:27], v[56:59], 0
    v_mfma_f32_16x16x32_bf16 a[20:23], v[28:31], v[56:59], 0
    v_mfma_f32_16x16x32_bf16 v[132:135], v[12:15], v[52:55], 0
    v_perm_b32 v56, v65, v61, s69
    v_perm_b32 v57, v73, v69, s69
    v_mfma_f32_16x16x32_bf16 v[156:159], v[16:19], v[52:55], 0
    v_perm_b32 v58, v81, v77, s69
    v_perm_b32 v59, v89, v85, s69
    v_mfma_f32_16x16x32_bf16 v[180:183], v[20:23], v[52:55], 0
    v_mfma_f32_16x16x32_bf16 a[0:3], v[24:27], v[52:55], 0
    v_mfma_f32_16x16x32_bf16 a[24:27], v[28:31], v[52:55], 0
    v_mfma_f32_16x16x32_bf16 v[136:139], v[12:15], v[56:59], 0
    v_perm_b32 v52, v66, v62, s68
    v_perm_b32 v53, v74, v70, s68
    v_mfma_f32_16x16x32_bf16 v[160:163], v[16:19], v[56:59], 0
    v_perm_b32 v54, v82, v78, s68
    v_perm_b32 v55, v90, v86, s68
    v_mfma_f32_16x16x32_bf16 v[184:187], v[20:23], v[56:59], 0
    v_mfma_f32_16x16x32_bf16 a[4:7], v[24:27], v[56:59], 0
    v_mfma_f32_16x16x32_bf16 a[28:31], v[28:31], v[56:59], 0
    v_mfma_f32_16x16x32_bf16 v[140:143], v[12:15], v[52:55], 0
    v_perm_b32 v56, v66, v62, s69
    v_perm_b32 v57, v74, v70, s69
    v_mfma_f32_16x16x32_bf16 v[164:167], v[16:19], v[52:55], 0
    v_perm_b32 v58, v82, v78, s69
    v_perm_b32 v59, v90, v86, s69
    v_mfma_f32_16x16x32_bf16 v[188:191], v[20:23], v[52:55], 0
    v_mfma_f32_16x16x32_bf16 a[8:11], v[24:27], v[52:55], 0
    v_mfma_f32_16x16x32_bf16 a[32:35], v[28:31], v[52:55], 0
    v_mfma_f32_16x16x32_bf16 v[144:147], v[12:15], v[56:59], 0
    s_waitcnt vmcnt(2)
    v_perm_b32 v52, v96, v92, s68
    v_perm_b32 v53, v104, v100, s68
    v_mfma_f32_16x16x32_bf16 v[168:171], v[16:19], v[56:59], 0
    v_perm_b32 v54, v112, v108, s68
    v_perm_b32 v55, v120, v116, s68
    v_mfma_f32_16x16x32_bf16 v[192:195], v[20:23], v[56:59], 0
    s_mov_b32 s67, 98304
    buffer_load_dwordx3 v[60:62], v3, s[32:35], s67 offen offset:0
    buffer_load_dwordx3 v[64:66], v3, s[32:35], s67 offen offset:1536
    buffer_load_dwordx3 v[68:70], v3, s[32:35], s67 offen offset:3072
    s_mov_b32 s67, 102912
    buffer_load_dwordx3 v[72:74], v3, s[32:35], s67 offen offset:0
    buffer_load_dwordx3 v[76:78], v3, s[32:35], s67 offen offset:1536
    buffer_load_dwordx3 v[80:82], v3, s[32:35], s67 offen offset:3072
    s_mov_b32 s67, 107520
    buffer_load_dwordx3 v[84:86], v3, s[32:35], s67 offen offset:0
    buffer_load_dwordx3 v[88:90], v3, s[32:35], s67 offen offset:1536
    v_mfma_f32_16x16x32_bf16 a[12:15], v[24:27], v[56:59], 0
    v_mfma_f32_16x16x32_bf16 a[36:39], v[28:31], v[56:59], 0
    ds_read_b128 v[12:15], v4 offset:128
    ds_read_b128 v[16:19], v4 offset:8832
    ds_read_b128 v[20:23], v4 offset:17536
    ds_read_b128 v[24:27], v4 offset:26240
    ds_read_b128 v[28:31], v4 offset:34944
    s_waitcnt lgkmcnt(5)
    v_mfma_f32_16x16x32_bf16 v[124:127], v[32:35], v[52:55], v[124:127]
    v_perm_b32 v56, v96, v92, s69
    v_perm_b32 v57, v104, v100, s69
    v_mfma_f32_16x16x32_bf16 v[148:151], v[36:39], v[52:55], v[148:151]
    v_perm_b32 v58, v112, v108, s69
    v_perm_b32 v59, v120, v116, s69
    v_mfma_f32_16x16x32_bf16 v[172:175], v[40:43], v[52:55], v[172:175]
    v_mfma_f32_16x16x32_bf16 v[196:199], v[44:47], v[52:55], v[196:199]
    v_mfma_f32_16x16x32_bf16 a[16:19], v[48:51], v[52:55], a[16:19]
    v_mfma_f32_16x16x32_bf16 v[128:131], v[32:35], v[56:59], v[128:131]
    v_perm_b32 v52, v97, v93, s68
    v_perm_b32 v53, v105, v101, s68
    v_mfma_f32_16x16x32_bf16 v[152:155], v[36:39], v[56:59], v[152:155]
    v_perm_b32 v54, v113, v109, s68
    v_perm_b32 v55, v121, v117, s68
    v_mfma_f32_16x16x32_bf16 v[176:179], v[40:43], v[56:59], v[176:179]
    v_mfma_f32_16x16x32_bf16 v[200:203], v[44:47], v[56:59], v[200:203]
    v_mfma_f32_16x16x32_bf16 a[20:23], v[48:51], v[56:59], a[20:23]
    v_mfma_f32_16x16x32_bf16 v[132:135], v[32:35], v[52:55], v[132:135]
    v_perm_b32 v56, v97, v93, s69
    v_perm_b32 v57, v105, v101, s69
    v_mfma_f32_16x16x32_bf16 v[156:159], v[36:39], v[52:55], v[156:159]
    v_perm_b32 v58, v113, v109, s69
    v_perm_b32 v59, v121, v117, s69
    v_mfma_f32_16x16x32_bf16 v[180:183], v[40:43], v[52:55], v[180:183]
    v_mfma_f32_16x16x32_bf16 a[0:3], v[44:47], v[52:55], a[0:3]
    v_mfma_f32_16x16x32_bf16 a[24:27], v[48:51], v[52:55], a[24:27]
    v_mfma_f32_16x16x32_bf16 v[136:139], v[32:35], v[56:59], v[136:139]
    v_perm_b32 v52, v98, v94, s68
    v_perm_b32 v53, v106, v102, s68
    v_mfma_f32_16x16x32_bf16 v[160:163], v[36:39], v[56:59], v[160:163]
    v_perm_b32 v54, v114, v110, s68
    v_perm_b32 v55, v122, v118, s68
    v_mfma_f32_16x16x32_bf16 v[184:187], v[40:43], v[56:59], v[184:187]
    v_mfma_f32_16x16x32_bf16 a[4:7], v[44:47], v[56:59], a[4:7]
    v_mfma_f32_16x16x32_bf16 a[28:31], v[48:51], v[56:59], a[28:31]
    v_mfma_f32_16x16x32_bf16 v[140:143], v[32:35], v[52:55], v[140:143]
    v_perm_b32 v56, v98, v94, s69
    v_perm_b32 v57, v106, v102, s69
    v_mfma_f32_16x16x32_bf16 v[164:167], v[36:39], v[52:55], v[164:167]
    v_perm_b32 v58, v114, v110, s69
    v_perm_b32 v59, v122, v118, s69
    v_mfma_f32_16x16x32_bf16 v[188:191], v[40:43], v[52:55], v[188:191]
    v_mfma_f32_16x16x32_bf16 a[8:11], v[44:47], v[52:55], a[8:11]
    v_mfma_f32_16x16x32_bf16 a[32:35], v[48:51], v[52:55], a[32:35]
    v_mfma_f32_16x16x32_bf16 v[144:147], v[32:35], v[56:59], v[144:147]
    s_waitcnt vmcnt(0)
    v_perm_b32 v52, v64, v60, s68
    v_perm_b32 v53, v72, v68, s68
    v_mfma_f32_16x16x32_bf16 v[168:171], v[36:39], v[56:59], v[168:171]
    v_perm_b32 v54, v80, v76, s68
    v_perm_b32 v55, v88, v84, s68
    v_mfma_f32_16x16x32_bf16 v[192:195], v[40:43], v[56:59], v[192:195]
    s_mov_b32 s67, 147456
    buffer_load_dwordx3 v[92:94], v3, s[32:35], s67 offen offset:0
    buffer_load_dwordx3 v[96:98], v3, s[32:35], s67 offen offset:1536
    buffer_load_dwordx3 v[100:102], v3, s[32:35], s67 offen offset:3072
    s_mov_b32 s67, 152064
    buffer_load_dwordx3 v[104:106], v3, s[32:35], s67 offen offset:0
    buffer_load_dwordx3 v[108:110], v3, s[32:35], s67 offen offset:1536
    buffer_load_dwordx3 v[112:114], v3, s[32:35], s67 offen offset:3072
    s_mov_b32 s67, 156672
    buffer_load_dwordx3 v[116:118], v3, s[32:35], s67 offen offset:0
    buffer_load_dwordx3 v[120:122], v3, s[32:35], s67 offen offset:1536
    v_mfma_f32_16x16x32_bf16 a[12:15], v[44:47], v[56:59], a[12:15]
    v_mfma_f32_16x16x32_bf16 a[36:39], v[48:51], v[56:59], a[36:39]
    ds_read_b128 v[32:35], v4 offset:192
    ds_read_b128 v[36:39], v4 offset:8896
    ds_read_b128 v[40:43], v4 offset:17600
    ds_read_b128 v[44:47], v4 offset:26304
    ds_read_b128 v[48:51], v4 offset:35008
    s_waitcnt lgkmcnt(5)
    v_mfma_f32_16x16x32_bf16 v[124:127], v[12:15], v[52:55], v[124:127]
    v_perm_b32 v56, v64, v60, s69
    v_perm_b32 v57, v72, v68, s69
    v_mfma_f32_16x16x32_bf16 v[148:151], v[16:19], v[52:55], v[148:151]
    v_perm_b32 v58, v80, v76, s69
    v_perm_b32 v59, v88, v84, s69
    v_mfma_f32_16x16x32_bf16 v[172:175], v[20:23], v[52:55], v[172:175]
    v_mfma_f32_16x16x32_bf16 v[196:199], v[24:27], v[52:55], v[196:199]
    v_mfma_f32_16x16x32_bf16 a[16:19], v[28:31], v[52:55], a[16:19]
    v_mfma_f32_16x16x32_bf16 v[128:131], v[12:15], v[56:59], v[128:131]
    v_perm_b32 v52, v65, v61, s68
    v_perm_b32 v53, v73, v69, s68
    v_mfma_f32_16x16x32_bf16 v[152:155], v[16:19], v[56:59], v[152:155]
    v_perm_b32 v54, v81, v77, s68
    v_perm_b32 v55, v89, v85, s68
    v_mfma_f32_16x16x32_bf16 v[176:179], v[20:23], v[56:59], v[176:179]
    v_mfma_f32_16x16x32_bf16 v[200:203], v[24:27], v[56:59], v[200:203]
    v_mfma_f32_16x16x32_bf16 a[20:23], v[28:31], v[56:59], a[20:23]
    v_mfma_f32_16x16x32_bf16 v[132:135], v[12:15], v[52:55], v[132:135]
    v_perm_b32 v56, v65, v61, s69
    v_perm_b32 v57, v73, v69, s69
    v_mfma_f32_16x16x32_bf16 v[156:159], v[16:19], v[52:55], v[156:159]
    v_perm_b32 v58, v81, v77, s69
    v_perm_b32 v59, v89, v85, s69
    v_mfma_f32_16x16x32_bf16 v[180:183], v[20:23], v[52:55], v[180:183]
    v_mfma_f32_16x16x32_bf16 a[0:3], v[24:27], v[52:55], a[0:3]
    v_mfma_f32_16x16x32_bf16 a[24:27], v[28:31], v[52:55], a[24:27]
    v_mfma_f32_16x16x32_bf16 v[136:139], v[12:15], v[56:59], v[136:139]
    v_perm_b32 v52, v66, v62, s68
    v_perm_b32 v53, v74, v70, s68
    v_mfma_f32_16x16x32_bf16 v[160:163], v[16:19], v[56:59], v[160:163]
    v_perm_b32 v54, v82, v78, s68
    v_perm_b32 v55, v90, v86, s68
    v_mfma_f32_16x16x32_bf16 v[184:187], v[20:23], v[56:59], v[184:187]
    v_mfma_f32_16x16x32_bf16 a[4:7], v[24:27], v[56:59], a[4:7]
    v_mfma_f32_16x16x32_bf16 a[28:31], v[28:31], v[56:59], a[28:31]
    v_mfma_f32_16x16x32_bf16 v[140:143], v[12:15], v[52:55], v[140:143]
    v_perm_b32 v56, v66, v62, s69
    v_perm_b32 v57, v74, v70, s69
    v_mfma_f32_16x16x32_bf16 v[164:167], v[16:19], v[52:55], v[164:167]
    v_perm_b32 v58, v82, v78, s69
    v_perm_b32 v59, v90, v86, s69
    v_mfma_f32_16x16x32_bf16 v[188:191], v[20:23], v[52:55], v[188:191]
    v_mfma_f32_16x16x32_bf16 a[8:11], v[24:27], v[52:55], a[8:11]
    v_mfma_f32_16x16x32_bf16 a[32:35], v[28:31], v[52:55], a[32:35]
    v_mfma_f32_16x16x32_bf16 v[144:147], v[12:15], v[56:59], v[144:147]
    s_waitcnt vmcnt(0)
    v_perm_b32 v52, v96, v92, s68
    v_perm_b32 v53, v104, v100, s68
    v_mfma_f32_16x16x32_bf16 v[168:171], v[16:19], v[56:59], v[168:171]
    v_perm_b32 v54, v112, v108, s68
    v_perm_b32 v55, v120, v116, s68
    v_mfma_f32_16x16x32_bf16 v[192:195], v[20:23], v[56:59], v[192:195]
    s_mov_b32 s67, 196608
    buffer_load_dwordx3 v[60:62], v3, s[32:35], s67 offen offset:0
    buffer_load_dwordx3 v[64:66], v3, s[32:35], s67 offen offset:1536
    buffer_load_dwordx3 v[68:70], v3, s[32:35], s67 offen offset:3072
    s_mov_b32 s67, 201216
    buffer_load_dwordx3 v[72:74], v3, s[32:35], s67 offen offset:0
    buffer_load_dwordx3 v[76:78], v3, s[32:35], s67 offen offset:1536
    buffer_load_dwordx3 v[80:82], v3, s[32:35], s67 offen offset:3072
    s_mov_b32 s67, 205824
    buffer_load_dwordx3 v[84:86], v3, s[32:35], s67 offen offset:0
    buffer_load_dwordx3 v[88:90], v3, s[32:35], s67 offen offset:1536
    v_mfma_f32_16x16x32_bf16 a[12:15], v[24:27], v[56:59], a[12:15]
    v_mfma_f32_16x16x32_bf16 a[36:39], v[28:31], v[56:59], a[36:39]
    ds_read_b128 v[12:15], v4 offset:256
    ds_read_b128 v[16:19], v4 offset:8960
    ds_read_b128 v[20:23], v4 offset:17664
    ds_read_b128 v[24:27], v4 offset:26368
    ds_read_b128 v[28:31], v4 offset:35072
    s_waitcnt lgkmcnt(5)
    v_mfma_f32_16x16x32_bf16 v[124:127], v[32:35], v[52:55], v[124:127]
    v_perm_b32 v56, v96, v92, s69
    v_perm_b32 v57, v104, v100, s69
    v_mfma_f32_16x16x32_bf16 v[148:151], v[36:39], v[52:55], v[148:151]
    v_perm_b32 v58, v112, v108, s69
    v_perm_b32 v59, v120, v116, s69
    v_mfma_f32_16x16x32_bf16 v[172:175], v[40:43], v[52:55], v[172:175]
    v_mfma_f32_16x16x32_bf16 v[196:199], v[44:47], v[52:55], v[196:199]
    v_mfma_f32_16x16x32_bf16 a[16:19], v[48:51], v[52:55], a[16:19]
    v_mfma_f32_16x16x32_bf16 v[128:131], v[32:35], v[56:59], v[128:131]
    v_perm_b32 v52, v97, v93, s68
    v_perm_b32 v53, v105, v101, s68
    v_mfma_f32_16x16x32_bf16 v[152:155], v[36:39], v[56:59], v[152:155]
    v_perm_b32 v54, v113, v109, s68
    v_perm_b32 v55, v121, v117, s68
    v_mfma_f32_16x16x32_bf16 v[176:179], v[40:43], v[56:59], v[176:179]
    v_mfma_f32_16x16x32_bf16 v[200:203], v[44:47], v[56:59], v[200:203]
    v_mfma_f32_16x16x32_bf16 a[20:23], v[48:51], v[56:59], a[20:23]
    v_mfma_f32_16x16x32_bf16 v[132:135], v[32:35], v[52:55], v[132:135]
    v_perm_b32 v56, v97, v93, s69
    v_perm_b32 v57, v105, v101, s69
    v_mfma_f32_16x16x32_bf16 v[156:159], v[36:39], v[52:55], v[156:159]
    v_perm_b32 v58, v113, v109, s69
    v_perm_b32 v59, v121, v117, s69
    v_mfma_f32_16x16x32_bf16 v[180:183], v[40:43], v[52:55], v[180:183]
    v_mfma_f32_16x16x32_bf16 a[0:3], v[44:47], v[52:55], a[0:3]
    v_mfma_f32_16x16x32_bf16 a[24:27], v[48:51], v[52:55], a[24:27]
    v_mfma_f32_16x16x32_bf16 v[136:139], v[32:35], v[56:59], v[136:139]
    v_perm_b32 v52, v98, v94, s68
    v_perm_b32 v53, v106, v102, s68
    v_mfma_f32_16x16x32_bf16 v[160:163], v[36:39], v[56:59], v[160:163]
    v_perm_b32 v54, v114, v110, s68
    v_perm_b32 v55, v122, v118, s68
    v_mfma_f32_16x16x32_bf16 v[184:187], v[40:43], v[56:59], v[184:187]
    v_mfma_f32_16x16x32_bf16 a[4:7], v[44:47], v[56:59], a[4:7]
    v_mfma_f32_16x16x32_bf16 a[28:31], v[48:51], v[56:59], a[28:31]
    v_mfma_f32_16x16x32_bf16 v[140:143], v[32:35], v[52:55], v[140:143]
    v_perm_b32 v56, v98, v94, s69
    v_perm_b32 v57, v106, v102, s69
    v_mfma_f32_16x16x32_bf16 v[164:167], v[36:39], v[52:55], v[164:167]
    v_perm_b32 v58, v114, v110, s69
    v_perm_b32 v59, v122, v118, s69
    v_mfma_f32_16x16x32_bf16 v[188:191], v[40:43], v[52:55], v[188:191]
    v_mfma_f32_16x16x32_bf16 a[8:11], v[44:47], v[52:55], a[8:11]
    v_mfma_f32_16x16x32_bf16 a[32:35], v[48:51], v[52:55], a[32:35]
    v_mfma_f32_16x16x32_bf16 v[144:147], v[32:35], v[56:59], v[144:147]
    s_waitcnt vmcnt(0)
    v_perm_b32 v52, v64, v60, s68
    v_perm_b32 v53, v72, v68, s68
    v_mfma_f32_16x16x32_bf16 v[168:171], v[36:39], v[56:59], v[168:171]
    v_perm_b32 v54, v80, v76, s68
    v_perm_b32 v55, v88, v84, s68
    v_mfma_f32_16x16x32_bf16 v[192:195], v[40:43], v[56:59], v[192:195]
    s_mov_b32 s67, 245760
    buffer_load_dwordx3 v[92:94], v3, s[32:35], s67 offen offset:0
    buffer_load_dwordx3 v[96:98], v3, s[32:35], s67 offen offset:1536
    buffer_load_dwordx3 v[100:102], v3, s[32:35], s67 offen offset:3072
    s_mov_b32 s67, 250368
    buffer_load_dwordx3 v[104:106], v3, s[32:35], s67 offen offset:0
    buffer_load_dwordx3 v[108:110], v3, s[32:35], s67 offen offset:1536
    buffer_load_dwordx3 v[112:114], v3, s[32:35], s67 offen offset:3072
    s_mov_b32 s67, 254976
    buffer_load_dwordx3 v[116:118], v3, s[32:35], s67 offen offset:0
    buffer_load_dwordx3 v[120:122], v3, s[32:35], s67 offen offset:1536
    v_mfma_f32_16x16x32_bf16 a[12:15], v[44:47], v[56:59], a[12:15]
    v_mfma_f32_16x16x32_bf16 a[36:39], v[48:51], v[56:59], a[36:39]
    ds_read_b128 v[32:35], v4 offset:320
    ds_read_b128 v[36:39], v4 offset:9024
    ds_read_b128 v[40:43], v4 offset:17728
    ds_read_b128 v[44:47], v4 offset:26432
    ds_read_b128 v[48:51], v4 offset:35136
    s_waitcnt lgkmcnt(5)
    v_mfma_f32_16x16x32_bf16 v[124:127], v[12:15], v[52:55], v[124:127]
    v_perm_b32 v56, v64, v60, s69
    v_perm_b32 v57, v72, v68, s69
    v_mfma_f32_16x16x32_bf16 v[148:151], v[16:19], v[52:55], v[148:151]
    v_perm_b32 v58, v80, v76, s69
    v_perm_b32 v59, v88, v84, s69
    v_mfma_f32_16x16x32_bf16 v[172:175], v[20:23], v[52:55], v[172:175]
    v_mfma_f32_16x16x32_bf16 v[196:199], v[24:27], v[52:55], v[196:199]
    v_mfma_f32_16x16x32_bf16 a[16:19], v[28:31], v[52:55], a[16:19]
    v_mfma_f32_16x16x32_bf16 v[128:131], v[12:15], v[56:59], v[128:131]
    v_perm_b32 v52, v65, v61, s68
    v_perm_b32 v53, v73, v69, s68
    v_mfma_f32_16x16x32_bf16 v[152:155], v[16:19], v[56:59], v[152:155]
    v_perm_b32 v54, v81, v77, s68
    v_perm_b32 v55, v89, v85, s68
    v_mfma_f32_16x16x32_bf16 v[176:179], v[20:23], v[56:59], v[176:179]
    v_mfma_f32_16x16x32_bf16 v[200:203], v[24:27], v[56:59], v[200:203]
    v_mfma_f32_16x16x32_bf16 a[20:23], v[28:31], v[56:59], a[20:23]
    v_mfma_f32_16x16x32_bf16 v[132:135], v[12:15], v[52:55], v[132:135]
    v_perm_b32 v56, v65, v61, s69
    v_perm_b32 v57, v73, v69, s69
    v_mfma_f32_16x16x32_bf16 v[156:159], v[16:19], v[52:55], v[156:159]
    v_perm_b32 v58, v81, v77, s69
    v_perm_b32 v59, v89, v85, s69
    v_mfma_f32_16x16x32_bf16 v[180:183], v[20:23], v[52:55], v[180:183]
    v_mfma_f32_16x16x32_bf16 a[0:3], v[24:27], v[52:55], a[0:3]
    v_mfma_f32_16x16x32_bf16 a[24:27], v[28:31], v[52:55], a[24:27]
    v_mfma_f32_16x16x32_bf16 v[136:139], v[12:15], v[56:59], v[136:139]
    v_perm_b32 v52, v66, v62, s68
    v_perm_b32 v53, v74, v70, s68
    v_mfma_f32_16x16x32_bf16 v[160:163], v[16:19], v[56:59], v[160:163]
    v_perm_b32 v54, v82, v78, s68
    v_perm_b32 v55, v90, v86, s68
    v_mfma_f32_16x16x32_bf16 v[184:187], v[20:23], v[56:59], v[184:187]
    v_mfma_f32_16x16x32_bf16 a[4:7], v[24:27], v[56:59], a[4:7]
    v_mfma_f32_16x16x32_bf16 a[28:31], v[28:31], v[56:59], a[28:31]
    v_mfma_f32_16x16x32_bf16 v[140:143], v[12:15], v[52:55], v[140:143]
    v_perm_b32 v56, v66, v62, s69
    v_perm_b32 v57, v74, v70, s69
    v_mfma_f32_16x16x32_bf16 v[164:167], v[16:19], v[52:55], v[164:167]
    v_perm_b32 v58, v82, v78, s69
    v_perm_b32 v59, v90, v86, s69
    v_mfma_f32_16x16x32_bf16 v[188:191], v[20:23], v[52:55], v[188:191]
    v_mfma_f32_16x16x32_bf16 a[8:11], v[24:27], v[52:55], a[8:11]
    v_mfma_f32_16x16x32_bf16 a[32:35], v[28:31], v[52:55], a[32:35]
    v_mfma_f32_16x16x32_bf16 v[144:147], v[12:15], v[56:59], v[144:147]
    s_waitcnt vmcnt(0)
    v_perm_b32 v52, v96, v92, s68
    v_perm_b32 v53, v104, v100, s68
    v_mfma_f32_16x16x32_bf16 v[168:171], v[16:19], v[56:59], v[168:171]
    v_perm_b32 v54, v112, v108, s68
    v_perm_b32 v55, v120, v116, s68
    v_mfma_f32_16x16x32_bf16 v[192:195], v[20:23], v[56:59], v[192:195]
    s_mov_b32 s67, 294912
    buffer_load_dwordx3 v[60:62], v3, s[32:35], s67 offen offset:0
    buffer_load_dwordx3 v[64:66], v3, s[32:35], s67 offen offset:1536
    buffer_load_dwordx3 v[68:70], v3, s[32:35], s67 offen offset:3072
    s_mov_b32 s67, 299520
    buffer_load_dwordx3 v[72:74], v3, s[32:35], s67 offen offset:0
    buffer_load_dwordx3 v[76:78], v3, s[32:35], s67 offen offset:1536
    buffer_load_dwordx3 v[80:82], v3, s[32:35], s67 offen offset:3072
    s_mov_b32 s67, 304128
    buffer_load_dwordx3 v[84:86], v3, s[32:35], s67 offen offset:0
    buffer_load_dwordx3 v[88:90], v3, s[32:35], s67 offen offset:1536
    v_mfma_f32_16x16x32_bf16 a[12:15], v[24:27], v[56:59], a[12:15]
    v_mfma_f32_16x16x32_bf16 a[36:39], v[28:31], v[56:59], a[36:39]
    ds_read_b128 v[12:15], v4 offset:384
    ds_read_b128 v[16:19], v4 offset:9088
    ds_read_b128 v[20:23], v4 offset:17792
    ds_read_b128 v[24:27], v4 offset:26496
    ds_read_b128 v[28:31], v4 offset:35200
    s_waitcnt lgkmcnt(5)
    v_mfma_f32_16x16x32_bf16 v[124:127], v[32:35], v[52:55], v[124:127]
    v_perm_b32 v56, v96, v92, s69
    v_perm_b32 v57, v104, v100, s69
    v_mfma_f32_16x16x32_bf16 v[148:151], v[36:39], v[52:55], v[148:151]
    v_perm_b32 v58, v112, v108, s69
    v_perm_b32 v59, v120, v116, s69
    v_mfma_f32_16x16x32_bf16 v[172:175], v[40:43], v[52:55], v[172:175]
    v_mfma_f32_16x16x32_bf16 v[196:199], v[44:47], v[52:55], v[196:199]
    v_mfma_f32_16x16x32_bf16 a[16:19], v[48:51], v[52:55], a[16:19]
    v_mfma_f32_16x16x32_bf16 v[128:131], v[32:35], v[56:59], v[128:131]
    v_perm_b32 v52, v97, v93, s68
    v_perm_b32 v53, v105, v101, s68
    v_mfma_f32_16x16x32_bf16 v[152:155], v[36:39], v[56:59], v[152:155]
    v_perm_b32 v54, v113, v109, s68
    v_perm_b32 v55, v121, v117, s68
    v_mfma_f32_16x16x32_bf16 v[176:179], v[40:43], v[56:59], v[176:179]
    v_mfma_f32_16x16x32_bf16 v[200:203], v[44:47], v[56:59], v[200:203]
    v_mfma_f32_16x16x32_bf16 a[20:23], v[48:51], v[56:59], a[20:23]
    v_mfma_f32_16x16x32_bf16 v[132:135], v[32:35], v[52:55], v[132:135]
    v_perm_b32 v56, v97, v93, s69
    v_perm_b32 v57, v105, v101, s69
    v_mfma_f32_16x16x32_bf16 v[156:159], v[36:39], v[52:55], v[156:159]
    v_perm_b32 v58, v113, v109, s69
    v_perm_b32 v59, v121, v117, s69
    v_mfma_f32_16x16x32_bf16 v[180:183], v[40:43], v[52:55], v[180:183]
    v_mfma_f32_16x16x32_bf16 a[0:3], v[44:47], v[52:55], a[0:3]
    v_mfma_f32_16x16x32_bf16 a[24:27], v[48:51], v[52:55], a[24:27]
    v_mfma_f32_16x16x32_bf16 v[136:139], v[32:35], v[56:59], v[136:139]
    v_perm_b32 v52, v98, v94, s68
    v_perm_b32 v53, v106, v102, s68
    v_mfma_f32_16x16x32_bf16 v[160:163], v[36:39], v[56:59], v[160:163]
    v_perm_b32 v54, v114, v110, s68
    v_perm_b32 v55, v122, v118, s68
    v_mfma_f32_16x16x32_bf16 v[184:187], v[40:43], v[56:59], v[184:187]
    v_mfma_f32_16x16x32_bf16 a[4:7], v[44:47], v[56:59], a[4:7]
    v_mfma_f32_16x16x32_bf16 a[28:31], v[48:51], v[56:59], a[28:31]
    v_mfma_f32_16x16x32_bf16 v[140:143], v[32:35], v[52:55], v[140:143]
    v_perm_b32 v56, v98, v94, s69
    v_perm_b32 v57, v106, v102, s69
    v_mfma_f32_16x16x32_bf16 v[164:167], v[36:39], v[52:55], v[164:167]
    v_perm_b32 v58, v114, v110, s69
    v_perm_b32 v59, v122, v118, s69
    v_mfma_f32_16x16x32_bf16 v[188:191], v[40:43], v[52:55], v[188:191]
    v_mfma_f32_16x16x32_bf16 a[8:11], v[44:47], v[52:55], a[8:11]
    v_mfma_f32_16x16x32_bf16 a[32:35], v[48:51], v[52:55], a[32:35]
    v_mfma_f32_16x16x32_bf16 v[144:147], v[32:35], v[56:59], v[144:147]
    s_waitcnt vmcnt(0)
    v_perm_b32 v52, v64, v60, s68
    v_perm_b32 v53, v72, v68, s68
    v_mfma_f32_16x16x32_bf16 v[168:171], v[36:39], v[56:59], v[168:171]
    v_perm_b32 v54, v80, v76, s68
    v_perm_b32 v55, v88, v84, s68
    v_mfma_f32_16x16x32_bf16 v[192:195], v[40:43], v[56:59], v[192:195]
    s_mov_b32 s67, 344064
    buffer_load_dwordx3 v[92:94], v3, s[32:35], s67 offen offset:0
    buffer_load_dwordx3 v[96:98], v3, s[32:35], s67 offen offset:1536
    buffer_load_dwordx3 v[100:102], v3, s[32:35], s67 offen offset:3072
    s_mov_b32 s67, 348672
    buffer_load_dwordx3 v[104:106], v3, s[32:35], s67 offen offset:0
    buffer_load_dwordx3 v[108:110], v3, s[32:35], s67 offen offset:1536
    buffer_load_dwordx3 v[112:114], v3, s[32:35], s67 offen offset:3072
    s_mov_b32 s67, 353280
    buffer_load_dwordx3 v[116:118], v3, s[32:35], s67 offen offset:0
    buffer_load_dwordx3 v[120:122], v3, s[32:35], s67 offen offset:1536
    v_mfma_f32_16x16x32_bf16 a[12:15], v[44:47], v[56:59], a[12:15]
    v_mfma_f32_16x16x32_bf16 a[36:39], v[48:51], v[56:59], a[36:39]
    ds_read_b128 v[32:35], v4 offset:448
    ds_read_b128 v[36:39], v4 offset:9152
    ds_read_b128 v[40:43], v4 offset:17856
    ds_read_b128 v[44:47], v4 offset:26560
    ds_read_b128 v[48:51], v4 offset:35264
    s_waitcnt lgkmcnt(5)
    v_mfma_f32_16x16x32_bf16 v[124:127], v[12:15], v[52:55], v[124:127]
    v_perm_b32 v56, v64, v60, s69
    v_perm_b32 v57, v72, v68, s69
    v_mfma_f32_16x16x32_bf16 v[148:151], v[16:19], v[52:55], v[148:151]
    v_perm_b32 v58, v80, v76, s69
    v_perm_b32 v59, v88, v84, s69
    v_mfma_f32_16x16x32_bf16 v[172:175], v[20:23], v[52:55], v[172:175]
    v_mfma_f32_16x16x32_bf16 v[196:199], v[24:27], v[52:55], v[196:199]
    v_mfma_f32_16x16x32_bf16 a[16:19], v[28:31], v[52:55], a[16:19]
    v_mfma_f32_16x16x32_bf16 v[128:131], v[12:15], v[56:59], v[128:131]
    v_perm_b32 v52, v65, v61, s68
    v_perm_b32 v53, v73, v69, s68
    v_mfma_f32_16x16x32_bf16 v[152:155], v[16:19], v[56:59], v[152:155]
    v_perm_b32 v54, v81, v77, s68
    v_perm_b32 v55, v89, v85, s68
    v_mfma_f32_16x16x32_bf16 v[176:179], v[20:23], v[56:59], v[176:179]
    v_mfma_f32_16x16x32_bf16 v[200:203], v[24:27], v[56:59], v[200:203]
    v_mfma_f32_16x16x32_bf16 a[20:23], v[28:31], v[56:59], a[20:23]
    v_mfma_f32_16x16x32_bf16 v[132:135], v[12:15], v[52:55], v[132:135]
    v_perm_b32 v56, v65, v61, s69
    v_perm_b32 v57, v73, v69, s69
    v_mfma_f32_16x16x32_bf16 v[156:159], v[16:19], v[52:55], v[156:159]
    v_perm_b32 v58, v81, v77, s69
    v_perm_b32 v59, v89, v85, s69
    v_mfma_f32_16x16x32_bf16 v[180:183], v[20:23], v[52:55], v[180:183]
    v_mfma_f32_16x16x32_bf16 a[0:3], v[24:27], v[52:55], a[0:3]
    v_mfma_f32_16x16x32_bf16 a[24:27], v[28:31], v[52:55], a[24:27]
    v_mfma_f32_16x16x32_bf16 v[136:139], v[12:15], v[56:59], v[136:139]
    v_perm_b32 v52, v66, v62, s68
    v_perm_b32 v53, v74, v70, s68
    v_mfma_f32_16x16x32_bf16 v[160:163], v[16:19], v[56:59], v[160:163]
    v_perm_b32 v54, v82, v78, s68
    v_perm_b32 v55, v90, v86, s68
    v_mfma_f32_16x16x32_bf16 v[184:187], v[20:23], v[56:59], v[184:187]
    v_mfma_f32_16x16x32_bf16 a[4:7], v[24:27], v[56:59], a[4:7]
    v_mfma_f32_16x16x32_bf16 a[28:31], v[28:31], v[56:59], a[28:31]
    v_mfma_f32_16x16x32_bf16 v[140:143], v[12:15], v[52:55], v[140:143]
    v_perm_b32 v56, v66, v62, s69
    v_perm_b32 v57, v74, v70, s69
    v_mfma_f32_16x16x32_bf16 v[164:167], v[16:19], v[52:55], v[164:167]
    v_perm_b32 v58, v82, v78, s69
    v_perm_b32 v59, v90, v86, s69
    v_mfma_f32_16x16x32_bf16 v[188:191], v[20:23], v[52:55], v[188:191]
    v_mfma_f32_16x16x32_bf16 a[8:11], v[24:27], v[52:55], a[8:11]
    v_mfma_f32_16x16x32_bf16 a[32:35], v[28:31], v[52:55], a[32:35]
    v_mfma_f32_16x16x32_bf16 v[144:147], v[12:15], v[56:59], v[144:147]
    s_waitcnt vmcnt(0)
    v_perm_b32 v52, v96, v92, s68
    v_perm_b32 v53, v104, v100, s68
    v_mfma_f32_16x16x32_bf16 v[168:171], v[16:19], v[56:59], v[168:171]
    v_perm_b32 v54, v112, v108, s68
    v_perm_b32 v55, v120, v116, s68
    v_mfma_f32_16x16x32_bf16 v[192:195], v[20:23], v[56:59], v[192:195]
    v_mfma_f32_16x16x32_bf16 a[12:15], v[24:27], v[56:59], a[12:15]
    v_mfma_f32_16x16x32_bf16 a[36:39], v[28:31], v[56:59], a[36:39]
    s_waitcnt lgkmcnt(0)
    v_mfma_f32_16x16x32_bf16 v[124:127], v[32:35], v[52:55], v[124:127]
    v_perm_b32 v56, v96, v92, s69
    v_perm_b32 v57, v104, v100, s69
    v_mfma_f32_16x16x32_bf16 v[148:151], v[36:39], v[52:55], v[148:151]
    v_perm_b32 v58, v112, v108, s69
    v_perm_b32 v59, v120, v116, s69
    v_mfma_f32_16x16x32_bf16 v[172:175], v[40:43], v[52:55], v[172:175]
    v_mfma_f32_16x16x32_bf16 v[196:199], v[44:47], v[52:55], v[196:199]
    v_mfma_f32_16x16x32_bf16 a[16:19], v[48:51], v[52:55], a[16:19]
    v_mfma_f32_16x16x32_bf16 v[128:131], v[32:35], v[56:59], v[128:131]
    v_perm_b32 v52, v97, v93, s68
    v_perm_b32 v53, v105, v101, s68
    v_mfma_f32_16x16x32_bf16 v[152:155], v[36:39], v[56:59], v[152:155]
    v_perm_b32 v54, v113, v109, s68
    v_perm_b32 v55, v121, v117, s68
    v_mfma_f32_16x16x32_bf16 v[176:179], v[40:43], v[56:59], v[176:179]
    v_mfma_f32_16x16x32_bf16 v[200:203], v[44:47], v[56:59], v[200:203]
    v_mfma_f32_16x16x32_bf16 a[20:23], v[48:51], v[56:59], a[20:23]
    v_mfma_f32_16x16x32_bf16 v[132:135], v[32:35], v[52:55], v[132:135]
    v_perm_b32 v56, v97, v93, s69
    v_perm_b32 v57, v105, v101, s69
    v_mfma_f32_16x16x32_bf16 v[156:159], v[36:39], v[52:55], v[156:159]
    v_perm_b32 v58, v113, v109, s69
    v_perm_b32 v59, v121, v117, s69
    v_mfma_f32_16x16x32_bf16 v[180:183], v[40:43], v[52:55], v[180:183]
    v_mfma_f32_16x16x32_bf16 a[0:3], v[44:47], v[52:55], a[0:3]
    v_mfma_f32_16x16x32_bf16 a[24:27], v[48:51], v[52:55], a[24:27]
    v_mfma_f32_16x16x32_bf16 v[136:139], v[32:35], v[56:59], v[136:139]
    v_perm_b32 v52, v98, v94, s68
    v_perm_b32 v53, v106, v102, s68
    v_mfma_f32_16x16x32_bf16 v[160:163], v[36:39], v[56:59], v[160:163]
    v_perm_b32 v54, v114, v110, s68
    v_perm_b32 v55, v122, v118, s68
    v_mfma_f32_16x16x32_bf16 v[184:187], v[40:43], v[56:59], v[184:187]
    v_mfma_f32_16x16x32_bf16 a[4:7], v[44:47], v[56:59], a[4:7]
    v_mfma_f32_16x16x32_bf16 a[28:31], v[48:51], v[56:59], a[28:31]
    v_mfma_f32_16x16x32_bf16 v[140:143], v[32:35], v[52:55], v[140:143]
    v_perm_b32 v56, v98, v94, s69
    v_perm_b32 v57, v106, v102, s69
    v_mfma_f32_16x16x32_bf16 v[164:167], v[36:39], v[52:55], v[164:167]
    v_perm_b32 v58, v114, v110, s69
    v_perm_b32 v59, v122, v118, s69
    v_mfma_f32_16x16x32_bf16 v[188:191], v[40:43], v[52:55], v[188:191]
    v_mfma_f32_16x16x32_bf16 a[8:11], v[44:47], v[52:55], a[8:11]
    v_mfma_f32_16x16x32_bf16 a[32:35], v[48:51], v[52:55], a[32:35]
    v_mfma_f32_16x16x32_bf16 v[144:147], v[32:35], v[56:59], v[144:147]
    v_mfma_f32_16x16x32_bf16 v[168:171], v[36:39], v[56:59], v[168:171]
    v_mfma_f32_16x16x32_bf16 v[192:195], v[40:43], v[56:59], v[192:195]
    v_mfma_f32_16x16x32_bf16 a[12:15], v[44:47], v[56:59], a[12:15]
    v_mfma_f32_16x16x32_bf16 a[36:39], v[48:51], v[56:59], a[36:39]
    s_nop 7
    v_cvt_pk_bf16_f32 v12, v124, v128
    v_cvt_pk_bf16_f32 v13, v132, v136
    v_cvt_pk_bf16_f32 v14, v140, v144
    s_mov_b32 s67, 0
    buffer_store_dwordx3 v[12:14], v6, s[36:39], s67 offen sc0 sc1
    v_cvt_pk_bf16_f32 v22, v125, v129
    v_cvt_pk_bf16_f32 v23, v133, v137
    v_cvt_pk_bf16_f32 v24, v141, v145
    s_mov_b32 s67, 1536
    buffer_store_dwordx3 v[22:24], v6, s[36:39], s67 offen sc0 sc1
    v_cvt_pk_bf16_f32 v32, v126, v130
    v_cvt_pk_bf16_f32 v33, v134, v138
    v_cvt_pk_bf16_f32 v34, v142, v146
    s_mov_b32 s67, 3072
    buffer_store_dwordx3 v[32:34], v6, s[36:39], s67 offen sc0 sc1
    v_cvt_pk_bf16_f32 v42, v127, v131
    v_cvt_pk_bf16_f32 v43, v135, v139
    v_cvt_pk_bf16_f32 v44, v143, v147
    s_mov_b32 s67, 4608
    buffer_store_dwordx3 v[42:44], v6, s[36:39], s67 offen sc0 sc1
    v_cvt_pk_bf16_f32 v12, v148, v152
    v_cvt_pk_bf16_f32 v13, v156, v160
    v_cvt_pk_bf16_f32 v14, v164, v168
    s_mov_b32 s67, 24576
    buffer_store_dwordx3 v[12:14], v6, s[36:39], s67 offen sc0 sc1
    v_cvt_pk_bf16_f32 v22, v149, v153
    v_cvt_pk_bf16_f32 v23, v157, v161
    v_cvt_pk_bf16_f32 v24, v165, v169
    s_mov_b32 s67, 26112
    buffer_store_dwordx3 v[22:24], v6, s[36:39], s67 offen sc0 sc1
    v_cvt_pk_bf16_f32 v32, v150, v154
    v_cvt_pk_bf16_f32 v33, v158, v162
    v_cvt_pk_bf16_f32 v34, v166, v170
    s_mov_b32 s67, 27648
    buffer_store_dwordx3 v[32:34], v6, s[36:39], s67 offen sc0 sc1
    v_cvt_pk_bf16_f32 v42, v151, v155
    v_cvt_pk_bf16_f32 v43, v159, v163
    v_cvt_pk_bf16_f32 v44, v167, v171
    s_mov_b32 s67, 29184
    buffer_store_dwordx3 v[42:44], v6, s[36:39], s67 offen sc0 sc1
    v_cvt_pk_bf16_f32 v12, v172, v176
    v_cvt_pk_bf16_f32 v13, v180, v184
    v_cvt_pk_bf16_f32 v14, v188, v192
    s_mov_b32 s67, 49152
    buffer_store_dwordx3 v[12:14], v6, s[36:39], s67 offen sc0 sc1
    v_cvt_pk_bf16_f32 v22, v173, v177
    v_cvt_pk_bf16_f32 v23, v181, v185
    v_cvt_pk_bf16_f32 v24, v189, v193
    s_mov_b32 s67, 50688
    buffer_store_dwordx3 v[22:24], v6, s[36:39], s67 offen sc0 sc1
    v_cvt_pk_bf16_f32 v32, v174, v178
    v_cvt_pk_bf16_f32 v33, v182, v186
    v_cvt_pk_bf16_f32 v34, v190, v194
    s_mov_b32 s67, 52224
    buffer_store_dwordx3 v[32:34], v6, s[36:39], s67 offen sc0 sc1
    v_cvt_pk_bf16_f32 v42, v175, v179
    v_cvt_pk_bf16_f32 v43, v183, v187
    v_cvt_pk_bf16_f32 v44, v191, v195
    s_mov_b32 s67, 53760
    buffer_store_dwordx3 v[42:44], v6, s[36:39], s67 offen sc0 sc1
    v_accvgpr_read_b32 v18, a0
    v_accvgpr_read_b32 v19, a4
    v_accvgpr_read_b32 v20, a8
    v_accvgpr_read_b32 v21, a12
    v_cvt_pk_bf16_f32 v12, v196, v200
    v_cvt_pk_bf16_f32 v13, v18, v19
    v_cvt_pk_bf16_f32 v14, v20, v21
    s_mov_b32 s67, 73728
    buffer_store_dwordx3 v[12:14], v6, s[36:39], s67 offen sc0 sc1
    v_accvgpr_read_b32 v28, a1
    v_accvgpr_read_b32 v29, a5
    v_accvgpr_read_b32 v30, a9
    v_accvgpr_read_b32 v31, a13
    v_cvt_pk_bf16_f32 v22, v197, v201
    v_cvt_pk_bf16_f32 v23, v28, v29
    v_cvt_pk_bf16_f32 v24, v30, v31
    s_mov_b32 s67, 75264
    buffer_store_dwordx3 v[22:24], v6, s[36:39], s67 offen sc0 sc1
    v_accvgpr_read_b32 v38, a2
    v_accvgpr_read_b32 v39, a6
    v_accvgpr_read_b32 v40, a10
    v_accvgpr_read_b32 v41, a14
    v_cvt_pk_bf16_f32 v32, v198, v202
    v_cvt_pk_bf16_f32 v33, v38, v39
    v_cvt_pk_bf16_f32 v34, v40, v41
    s_mov_b32 s67, 76800
    buffer_store_dwordx3 v[32:34], v6, s[36:39], s67 offen sc0 sc1
    v_accvgpr_read_b32 v48, a3
    v_accvgpr_read_b32 v49, a7
    v_accvgpr_read_b32 v50, a11
    v_accvgpr_read_b32 v51, a15
    v_cvt_pk_bf16_f32 v42, v199, v203
    v_cvt_pk_bf16_f32 v43, v48, v49
    v_cvt_pk_bf16_f32 v44, v50, v51
    s_mov_b32 s67, 78336
    buffer_store_dwordx3 v[42:44], v6, s[36:39], s67 offen sc0 sc1
    v_accvgpr_read_b32 v16, a16
    v_accvgpr_read_b32 v17, a20
    v_accvgpr_read_b32 v18, a24
    v_accvgpr_read_b32 v19, a28
    v_accvgpr_read_b32 v20, a32
    v_accvgpr_read_b32 v21, a36
    v_cvt_pk_bf16_f32 v12, v16, v17
    v_cvt_pk_bf16_f32 v13, v18, v19
    v_cvt_pk_bf16_f32 v14, v20, v21
    s_mov_b32 s67, 98304
    buffer_store_dwordx3 v[12:14], v6, s[36:39], s67 offen sc0 sc1
    v_accvgpr_read_b32 v26, a17
    v_accvgpr_read_b32 v27, a21
    v_accvgpr_read_b32 v28, a25
    v_accvgpr_read_b32 v29, a29
    v_accvgpr_read_b32 v30, a33
    v_accvgpr_read_b32 v31, a37
    v_cvt_pk_bf16_f32 v22, v26, v27
    v_cvt_pk_bf16_f32 v23, v28, v29
    v_cvt_pk_bf16_f32 v24, v30, v31
    s_mov_b32 s67, 99840
    buffer_store_dwordx3 v[22:24], v6, s[36:39], s67 offen sc0 sc1
    v_accvgpr_read_b32 v36, a18
    v_accvgpr_read_b32 v37, a22
    v_accvgpr_read_b32 v38, a26
    v_accvgpr_read_b32 v39, a30
    v_accvgpr_read_b32 v40, a34
    v_accvgpr_read_b32 v41, a38
    v_cvt_pk_bf16_f32 v32, v36, v37
    v_cvt_pk_bf16_f32 v33, v38, v39
    v_cvt_pk_bf16_f32 v34, v40, v41
    s_mov_b32 s67, 101376
    buffer_store_dwordx3 v[32:34], v6, s[36:39], s67 offen sc0 sc1
    v_accvgpr_read_b32 v46, a19
    v_accvgpr_read_b32 v47, a23
    v_accvgpr_read_b32 v48, a27
    v_accvgpr_read_b32 v49, a31
    v_accvgpr_read_b32 v50, a35
    v_accvgpr_read_b32 v51, a39
    v_cvt_pk_bf16_f32 v42, v46, v47
    v_cvt_pk_bf16_f32 v43, v48, v49
    v_cvt_pk_bf16_f32 v44, v50, v51
    s_mov_b32 s67, 102912
    buffer_store_dwordx3 v[42:44], v6, s[36:39], s67 offen sc0 sc1
    s_endpgm
K1_PREP:
    s_mov_b32 s32, s16
    s_and_b32 s33, s17, 0xffff
    s_mov_b32 s34, 393216
    s_mov_b32 s35, 0x20000
    s_mov_b32 s40, s6
    s_and_b32 s41, s7, 0xffff
    s_mov_b32 s42, 60000
    s_mov_b32 s43, 0x20000
    s_mov_b32 s44, s8
    s_and_b32 s45, s9, 0xffff
    s_mov_b32 s46, 640000
    s_mov_b32 s47, 0x20000
    s_mov_b32 s48, s10
    s_and_b32 s49, s11, 0xffff
    s_mov_b32 s50, 640000
    s_mov_b32 s51, 0x20000
    s_add_u32 s52, s20, 16777216
    s_addc_u32 s53, s21, 0
    s_and_b32 s53, s53, 0xffff
    s_mov_b32 s54, 5120000
    s_mov_b32 s55, 0x20000
    s_add_u32 s56, s20, 23068672
    s_addc_u32 s57, s21, 0
    s_and_b32 s57, s57, 0xffff
    s_mov_b32 s58, 160000
    s_mov_b32 s59, 0x20000
    s_add_u32 s60, s20, 24117248
    s_addc_u32 s61, s21, 0
    s_and_b32 s61, s61, 0xffff
    s_mov_b32 s62, 1000
    s_mov_b32 s63, 0x20000
    s_mov_b32 s28, s12
    s_and_b32 s29, s13, 0xffff
    s_mov_b32 s30, 8
    s_mov_b32 s31, 0x20000
    s_mul_i32 s70, s2, 640
    s_sub_u32 s71, s64, 4
    s_mul_i32 s71, s71, 160
    s_add_u32 s71, s70, s71
    v_add_u32 v2, s71, v1
    v_lshlrev_b32 v2, 2, v2
    s_mov_b32 s92, s14
    s_and_b32 s93, s15, 0xffff
    s_mov_b32 s94, 131072
    s_mov_b32 s95, 0x20000
    s_lshr_b32 s3, s2, 3
    s_and_b32 s3, s3, 31
    v_subrev_u32 v3, 256, v0
    v_lshlrev_b32 v3, 4, v3
    s_lshl_b32 s70, s3, 12
    buffer_load_dwordx4 v[128:131], v3, s[92:95], s70 offen
    s_mul_i32 s70, s3, 12288
    buffer_load_dwordx4 v[132:135], v3, s[32:35], s70 offen
    s_add_u32 s70, s70, 4096
    buffer_load_dwordx4 v[136:139], v3, s[32:35], s70 offen
    s_add_u32 s70, s70, 4096
    buffer_load_dwordx4 v[140:143], v3, s[32:35], s70 offen
    s_add_u32 s70, s70, 4096
    s_waitcnt vmcnt(4)
    ds_write_b128 v7, v[12:15] offset:0
    ds_write_b128 v7, v[16:19] offset:8704
    ds_write_b128 v7, v[20:23] offset:17408
    ds_write_b128 v7, v[24:27] offset:26112
    ds_write_b128 v7, v[28:31] offset:34816
    s_waitcnt lgkmcnt(0)
    s_barrier
    buffer_load_dword v60, v2, s[44:47], 0 offen offset:0
    buffer_load_dword v64, v2, s[48:51], 0 offen offset:0
    buffer_load_dword v61, v2, s[44:47], 0 offen offset:256
    buffer_load_dword v65, v2, s[48:51], 0 offen offset:256
    buffer_load_dword v62, v2, s[44:47], 0 offen offset:512
    buffer_load_dword v66, v2, s[48:51], 0 offen offset:512
    v_mov_b32 v3, 0
    buffer_load_dwordx2 v[68:69], v3, s[28:31], 0 offen
    s_waitcnt vmcnt(0)
    v_mul_u32_u24 v3, 6, v60
    v_and_b32 v3, -4, v3
    buffer_load_dwordx2 v[70:71], v3, s[40:43], 0 offen
    v_mul_u32_u24 v3, 6, v64
    v_and_b32 v3, -4, v3
    buffer_load_dwordx2 v[72:73], v3, s[40:43], 0 offen
    v_mul_u32_u24 v3, 6, v61
    v_and_b32 v3, -4, v3
    buffer_load_dwordx2 v[74:75], v3, s[40:43], 0 offen
    v_mul_u32_u24 v3, 6, v65
    v_and_b32 v3, -4, v3
    buffer_load_dwordx2 v[76:77], v3, s[40:43], 0 offen
    v_mul_u32_u24 v3, 6, v62
    v_and_b32 v3, -4, v3
    buffer_load_dwordx2 v[78:79], v3, s[40:43], 0 offen
    v_mul_u32_u24 v3, 6, v66
    v_and_b32 v3, -4, v3
    buffer_load_dwordx2 v[80:81], v3, s[40:43], 0 offen
    v_readfirstlane_b32 s72, v68
    v_readfirstlane_b32 s73, v69
    s_nop 1
    s_lshl_b32 s74, s72, 16
    s_and_b32 s75, s72, 0xffff0000
    s_lshl_b32 s76, s73, 16
    s_and_b32 s77, s73, 0xffff0000
    s_mov_b32 s78, 0x40490fdb
    s_mov_b32 s79, 0x3e4ccccd
    s_mov_b32 s80, 0x322bcc77
    s_mov_b32 s81, 0x40a00000
    s_mov_b32 s82, 0xffff0000
    s_waitcnt vmcnt(4)
    v_and_b32 v3, 1, v60
    v_lshlrev_b32 v3, 4, v3
    v_lshrrev_b64 v[70:71], v3, v[70:71]
    v_and_b32 v3, 1, v64
    v_lshlrev_b32 v3, 4, v3
    v_lshrrev_b64 v[72:73], v3, v[72:73]
    v_lshlrev_b32 v10, 16, v70
    v_lshlrev_b32 v4, 16, v72
    v_sub_f32 v10, v10, v4
    v_and_b32 v11, s82, v70
    v_and_b32 v4, s82, v72
    v_sub_f32 v11, v11, v4
    v_lshlrev_b32 v12, 16, v71
    v_lshlrev_b32 v4, 16, v73
    v_sub_f32 v12, v12, v4
    v_cvt_pk_bf16_f32 v10, v10, v10
    v_and_b32 v10, s82, v10
    v_cvt_pk_bf16_f32 v11, v11, v11
    v_and_b32 v11, s82, v11
    v_cvt_pk_bf16_f32 v12, v12, v12
    v_and_b32 v12, s82, v12
    v_mul_f32 v13, v10, v10
    v_mul_f32 v14, v11, v11
    v_mul_f32 v15, v12, v12
    v_cvt_pk_bf16_f32 v13, v13, v13
    v_and_b32 v13, s82, v13
    v_cvt_pk_bf16_f32 v14, v14, v14
    v_and_b32 v14, s82, v14
    v_cvt_pk_bf16_f32 v15, v15, v15
    v_and_b32 v15, s82, v15
    v_add_f32 v13, v13, v14
    v_add_f32 v13, v13, v15
    v_cvt_pk_bf16_f32 v13, v13, v13
    v_and_b32 v13, s82, v13
    v_add_f32 v13, s80, v13
    v_cvt_pk_bf16_f32 v13, v13, v13
    v_and_b32 v13, s82, v13
    v_sqrt_f32 v13, v13
    s_nop 0
    v_cvt_pk_bf16_f32 v13, v13, v13
    v_and_b32 v13, s82, v13
    v_rcp_f32 v14, v13
    v_mul_f32 v15, s78, v13
    v_cvt_pk_bf16_f32 v15, v15, v15
    v_and_b32 v15, s82, v15
    v_mul_f32 v15, s79, v15
    v_cvt_pk_bf16_f32 v15, v15, v15
    v_and_b32 v15, s82, v15
    v_mul_f32 v15, 0.15915494, v15
    v_cos_f32 v15, v15
    s_nop 0
    v_cvt_pk_bf16_f32 v15, v15, v15
    v_and_b32 v15, s82, v15
    v_add_f32 v15, 1.0, v15
    v_cvt_pk_bf16_f32 v15, v15, v15
    v_and_b32 v15, s82, v15
    v_mul_f32 v104, 0.5, v15
    v_mul_f32 v16, s74, v13
    v_mul_f32 v17, s75, v13
    v_mul_f32 v18, s76, v13
    v_mul_f32 v19, s77, v13
    v_cvt_pk_bf16_f32 v16, v16, v16
    v_and_b32 v16, s82, v16
    v_cvt_pk_bf16_f32 v17, v17, v17
    v_and_b32 v17, s82, v17
    v_cvt_pk_bf16_f32 v18, v18, v18
    v_and_b32 v18, s82, v18
    v_cvt_pk_bf16_f32 v19, v19, v19
    v_and_b32 v19, s82, v19
    v_mul_f32 v16, 0.15915494, v16
    v_mul_f32 v17, 0.15915494, v17
    v_mul_f32 v18, 0.15915494, v18
    v_mul_f32 v19, 0.15915494, v19
    v_sin_f32 v16, v16
    v_sin_f32 v17, v17
    v_sin_f32 v18, v18
    v_sin_f32 v19, v19
    s_nop 0
    v_cvt_pk_bf16_f32 v16, v16, v16
    v_and_b32 v16, s82, v16
    v_cvt_pk_bf16_f32 v17, v17, v17
    v_and_b32 v17, s82, v17
    v_cvt_pk_bf16_f32 v18, v18, v18
    v_and_b32 v18, s82, v18
    v_cvt_pk_bf16_f32 v19, v19, v19
    v_and_b32 v19, s82, v19
    v_mul_f32 v16, v16, v14
    v_mul_f32 v17, v17, v14
    v_mul_f32 v18, v18, v14
    v_mul_f32 v19, v19, v14
    v_cvt_pk_bf16_f32 v102, v16, v17
    v_cvt_pk_bf16_f32 v103, v18, v19
    v_mul_f32 v10, v10, v14
    v_mul_f32 v11, v11, v14
    v_mul_f32 v12, v12, v14
    v_cvt_pk_bf16_f32 v10, v10, v10
    v_and_b32 v10, s82, v10
    v_cvt_pk_bf16_f32 v11, v11, v11
    v_and_b32 v11, s82, v11
    v_cvt_pk_bf16_f32 v12, v12, v12
    v_and_b32 v12, s82, v12
    v_mul_f32 v105, v10, v104
    v_mul_f32 v106, v11, v104
    v_mul_f32 v107, v12, v104
    v_mov_b32 v100, v60
    v_mov_b32 v101, v64
    v_cmp_gt_f32 s[84:85], s81, v13
    v_cmp_neq_f32 vcc, 0, v104
    s_nop 1
    s_and_b64 s[84:85], s[84:85], vcc
    s_waitcnt vmcnt(2)
    v_and_b32 v3, 1, v61
    v_lshlrev_b32 v3, 4, v3
    v_lshrrev_b64 v[74:75], v3, v[74:75]
    v_and_b32 v3, 1, v65
    v_lshlrev_b32 v3, 4, v3
    v_lshrrev_b64 v[76:77], v3, v[76:77]
    v_lshlrev_b32 v10, 16, v74
    v_lshlrev_b32 v4, 16, v76
    v_sub_f32 v10, v10, v4
    v_and_b32 v11, s82, v74
    v_and_b32 v4, s82, v76
    v_sub_f32 v11, v11, v4
    v_lshlrev_b32 v12, 16, v75
    v_lshlrev_b32 v4, 16, v77
    v_sub_f32 v12, v12, v4
    v_cvt_pk_bf16_f32 v10, v10, v10
    v_and_b32 v10, s82, v10
    v_cvt_pk_bf16_f32 v11, v11, v11
    v_and_b32 v11, s82, v11
    v_cvt_pk_bf16_f32 v12, v12, v12
    v_and_b32 v12, s82, v12
    v_mul_f32 v13, v10, v10
    v_mul_f32 v14, v11, v11
    v_mul_f32 v15, v12, v12
    v_cvt_pk_bf16_f32 v13, v13, v13
    v_and_b32 v13, s82, v13
    v_cvt_pk_bf16_f32 v14, v14, v14
    v_and_b32 v14, s82, v14
    v_cvt_pk_bf16_f32 v15, v15, v15
    v_and_b32 v15, s82, v15
    v_add_f32 v13, v13, v14
    v_add_f32 v13, v13, v15
    v_cvt_pk_bf16_f32 v13, v13, v13
    v_and_b32 v13, s82, v13
    v_add_f32 v13, s80, v13
    v_cvt_pk_bf16_f32 v13, v13, v13
    v_and_b32 v13, s82, v13
    v_sqrt_f32 v13, v13
    s_nop 0
    v_cvt_pk_bf16_f32 v13, v13, v13
    v_and_b32 v13, s82, v13
    v_rcp_f32 v14, v13
    v_mul_f32 v15, s78, v13
    v_cvt_pk_bf16_f32 v15, v15, v15
    v_and_b32 v15, s82, v15
    v_mul_f32 v15, s79, v15
    v_cvt_pk_bf16_f32 v15, v15, v15
    v_and_b32 v15, s82, v15
    v_mul_f32 v15, 0.15915494, v15
    v_cos_f32 v15, v15
    s_nop 0
    v_cvt_pk_bf16_f32 v15, v15, v15
    v_and_b32 v15, s82, v15
    v_add_f32 v15, 1.0, v15
    v_cvt_pk_bf16_f32 v15, v15, v15
    v_and_b32 v15, s82, v15
    v_mul_f32 v112, 0.5, v15
    v_mul_f32 v16, s74, v13
    v_mul_f32 v17, s75, v13
    v_mul_f32 v18, s76, v13
    v_mul_f32 v19, s77, v13
    v_cvt_pk_bf16_f32 v16, v16, v16
    v_and_b32 v16, s82, v16
    v_cvt_pk_bf16_f32 v17, v17, v17
    v_and_b32 v17, s82, v17
    v_cvt_pk_bf16_f32 v18, v18, v18
    v_and_b32 v18, s82, v18
    v_cvt_pk_bf16_f32 v19, v19, v19
    v_and_b32 v19, s82, v19
    v_mul_f32 v16, 0.15915494, v16
    v_mul_f32 v17, 0.15915494, v17
    v_mul_f32 v18, 0.15915494, v18
    v_mul_f32 v19, 0.15915494, v19
    v_sin_f32 v16, v16
    v_sin_f32 v17, v17
    v_sin_f32 v18, v18
    v_sin_f32 v19, v19
    s_nop 0
    v_cvt_pk_bf16_f32 v16, v16, v16
    v_and_b32 v16, s82, v16
    v_cvt_pk_bf16_f32 v17, v17, v17
    v_and_b32 v17, s82, v17
    v_cvt_pk_bf16_f32 v18, v18, v18
    v_and_b32 v18, s82, v18
    v_cvt_pk_bf16_f32 v19, v19, v19
    v_and_b32 v19, s82, v19
    v_mul_f32 v16, v16, v14
    v_mul_f32 v17, v17, v14
    v_mul_f32 v18, v18, v14
    v_mul_f32 v19, v19, v14
    v_cvt_pk_bf16_f32 v110, v16, v17
    v_cvt_pk_bf16_f32 v111, v18, v19
    v_mul_f32 v10, v10, v14
    v_mul_f32 v11, v11, v14
    v_mul_f32 v12, v12, v14
    v_cvt_pk_bf16_f32 v10, v10, v10
    v_and_b32 v10, s82, v10
    v_cvt_pk_bf16_f32 v11, v11, v11
    v_and_b32 v11, s82, v11
    v_cvt_pk_bf16_f32 v12, v12, v12
    v_and_b32 v12, s82, v12
    v_mul_f32 v113, v10, v112
    v_mul_f32 v114, v11, v112
    v_mul_f32 v115, v12, v112
    v_mov_b32 v108, v61
    v_mov_b32 v109, v65
    v_cmp_gt_f32 s[86:87], s81, v13
    v_cmp_neq_f32 vcc, 0, v112
    s_nop 1
    s_and_b64 s[86:87], s[86:87], vcc
    s_waitcnt vmcnt(0)
    v_and_b32 v3, 1, v62
    v_lshlrev_b32 v3, 4, v3
    v_lshrrev_b64 v[78:79], v3, v[78:79]
    v_and_b32 v3, 1, v66
    v_lshlrev_b32 v3, 4, v3
    v_lshrrev_b64 v[80:81], v3, v[80:81]
    v_lshlrev_b32 v10, 16, v78
    v_lshlrev_b32 v4, 16, v80
    v_sub_f32 v10, v10, v4
    v_and_b32 v11, s82, v78
    v_and_b32 v4, s82, v80
    v_sub_f32 v11, v11, v4
    v_lshlrev_b32 v12, 16, v79
    v_lshlrev_b32 v4, 16, v81
    v_sub_f32 v12, v12, v4
    v_cvt_pk_bf16_f32 v10, v10, v10
    v_and_b32 v10, s82, v10
    v_cvt_pk_bf16_f32 v11, v11, v11
    v_and_b32 v11, s82, v11
    v_cvt_pk_bf16_f32 v12, v12, v12
    v_and_b32 v12, s82, v12
    v_mul_f32 v13, v10, v10
    v_mul_f32 v14, v11, v11
    v_mul_f32 v15, v12, v12
    v_cvt_pk_bf16_f32 v13, v13, v13
    v_and_b32 v13, s82, v13
    v_cvt_pk_bf16_f32 v14, v14, v14
    v_and_b32 v14, s82, v14
    v_cvt_pk_bf16_f32 v15, v15, v15
    v_and_b32 v15, s82, v15
    v_add_f32 v13, v13, v14
    v_add_f32 v13, v13, v15
    v_cvt_pk_bf16_f32 v13, v13, v13
    v_and_b32 v13, s82, v13
    v_add_f32 v13, s80, v13
    v_cvt_pk_bf16_f32 v13, v13, v13
    v_and_b32 v13, s82, v13
    v_sqrt_f32 v13, v13
    s_nop 0
    v_cvt_pk_bf16_f32 v13, v13, v13
    v_and_b32 v13, s82, v13
    v_rcp_f32 v14, v13
    v_mul_f32 v15, s78, v13
    v_cvt_pk_bf16_f32 v15, v15, v15
    v_and_b32 v15, s82, v15
    v_mul_f32 v15, s79, v15
    v_cvt_pk_bf16_f32 v15, v15, v15
    v_and_b32 v15, s82, v15
    v_mul_f32 v15, 0.15915494, v15
    v_cos_f32 v15, v15
    s_nop 0
    v_cvt_pk_bf16_f32 v15, v15, v15
    v_and_b32 v15, s82, v15
    v_add_f32 v15, 1.0, v15
    v_cvt_pk_bf16_f32 v15, v15, v15
    v_and_b32 v15, s82, v15
    v_mul_f32 v120, 0.5, v15
    v_mul_f32 v16, s74, v13
    v_mul_f32 v17, s75, v13
    v_mul_f32 v18, s76, v13
    v_mul_f32 v19, s77, v13
    v_cvt_pk_bf16_f32 v16, v16, v16
    v_and_b32 v16, s82, v16
    v_cvt_pk_bf16_f32 v17, v17, v17
    v_and_b32 v17, s82, v17
    v_cvt_pk_bf16_f32 v18, v18, v18
    v_and_b32 v18, s82, v18
    v_cvt_pk_bf16_f32 v19, v19, v19
    v_and_b32 v19, s82, v19
    v_mul_f32 v16, 0.15915494, v16
    v_mul_f32 v17, 0.15915494, v17
    v_mul_f32 v18, 0.15915494, v18
    v_mul_f32 v19, 0.15915494, v19
    v_sin_f32 v16, v16
    v_sin_f32 v17, v17
    v_sin_f32 v18, v18
    v_sin_f32 v19, v19
    s_nop 0
    v_cvt_pk_bf16_f32 v16, v16, v16
    v_and_b32 v16, s82, v16
    v_cvt_pk_bf16_f32 v17, v17, v17
    v_and_b32 v17, s82, v17
    v_cvt_pk_bf16_f32 v18, v18, v18
    v_and_b32 v18, s82, v18
    v_cvt_pk_bf16_f32 v19, v19, v19
    v_and_b32 v19, s82, v19
    v_mul_f32 v16, v16, v14
    v_mul_f32 v17, v17, v14
    v_mul_f32 v18, v18, v14
    v_mul_f32 v19, v19, v14
    v_cvt_pk_bf16_f32 v118, v16, v17
    v_cvt_pk_bf16_f32 v119, v18, v19
    v_mul_f32 v10, v10, v14
    v_mul_f32 v11, v11, v14
    v_mul_f32 v12, v12, v14
    v_cvt_pk_bf16_f32 v10, v10, v10
    v_and_b32 v10, s82, v10
    v_cvt_pk_bf16_f32 v11, v11, v11
    v_and_b32 v11, s82, v11
    v_cvt_pk_bf16_f32 v12, v12, v12
    v_and_b32 v12, s82, v12
    v_mul_f32 v121, v10, v120
    v_mul_f32 v122, v11, v120
    v_mul_f32 v123, v12, v120
    v_mov_b32 v116, v62
    v_mov_b32 v117, v66
    v_cmp_gt_f32 s[88:89], s81, v13
    v_cmp_neq_f32 vcc, 0, v120
    s_nop 1
    s_and_b64 s[88:89], s[88:89], vcc
    s_mov_b32 s89, 0
    s_bcnt1_i32_b64 s90, s[84:85]
    s_bcnt1_i32_b64 s91, s[86:87]
    s_bcnt1_i32_b64 s92, s[88:89]
    s_add_u32 s93, s90, s91
    s_add_u32 s93, s93, s92
    s_add_u32 s94, s93, 0x10000
    v_mov_b32 v8, 87044
    v_mov_b32 v9, s94
    s_mov_b64 exec, 1
    ds_add_rtn_u32 v9, v8, v9
    s_waitcnt lgkmcnt(0)
    s_mov_b64 exec, -1
    v_readfirstlane_b32 s94, v9
    s_and_b32 s95, s94, 0xffff
    s_lshr_b32 s94, s94, 16
    s_mul_i32 s70, s2, 640
    s_add_u32 s96, s70, s95
    s_mov_b32 s97, 52429
    v_mbcnt_lo_u32_b32 v3, s84, 0
    v_mbcnt_hi_u32_b32 v3, s85, v3
    v_add_u32 v3, s96, v3
    v_lshlrev_b32 v4, 5, v3
    v_mul_lo_u32 v5, s97, v101
    v_lshrrev_b32 v5, 21, v5
    s_mov_b64 exec, s[84:85]
    s_cbranch_execz K1_NOREC0
    buffer_store_dwordx4 v[100:103], v4, s[52:55], 0 offen sc0 sc1
    buffer_store_dwordx4 v[104:107], v4, s[52:55], 0 offen offset:16 sc0 sc1
    buffer_store_byte v5, v3, s[56:59], 0 offen sc0 sc1
K1_NOREC0:
    s_mov_b64 exec, -1
    s_add_u32 s96, s96, s90
    s_nop 1
    v_mbcnt_lo_u32_b32 v3, s86, 0
    v_mbcnt_hi_u32_b32 v3, s87, v3
    v_add_u32 v3, s96, v3
    v_lshlrev_b32 v4, 5, v3
    v_mul_lo_u32 v5, s97, v109
    v_lshrrev_b32 v5, 21, v5
    s_mov_b64 exec, s[86:87]
    s_cbranch_execz K1_NOREC1
    buffer_store_dwordx4 v[108:111], v4, s[52:55], 0 offen sc0 sc1
    buffer_store_dwordx4 v[112:115], v4, s[52:55], 0 offen offset:16 sc0 sc1
    buffer_store_byte v5, v3, s[56:59], 0 offen sc0 sc1
K1_NOREC1:
    s_mov_b64 exec, -1
    s_add_u32 s96, s96, s91
    s_nop 1
    v_mbcnt_lo_u32_b32 v3, s88, 0
    v_mbcnt_hi_u32_b32 v3, s89, v3
    v_add_u32 v3, s96, v3
    v_lshlrev_b32 v4, 5, v3
    v_mul_lo_u32 v5, s97, v117
    v_lshrrev_b32 v5, 21, v5
    s_mov_b64 exec, s[88:89]
    s_cbranch_execz K1_NOREC2
    buffer_store_dwordx4 v[116:119], v4, s[52:55], 0 offen sc0 sc1
    buffer_store_dwordx4 v[120:123], v4, s[52:55], 0 offen offset:16 sc0 sc1
    buffer_store_byte v5, v3, s[56:59], 0 offen sc0 sc1
K1_NOREC2:
    s_mov_b64 exec, -1
    s_nop 1
    s_cmp_lg_u32 s94, 3
    s_cbranch_scc1 K1_END
    s_add_u32 s95, s95, s93
    v_mov_b32 v4, s95
    s_lshl_b32 s96, s2, 2
    v_mov_b32 v3, s96
    s_mov_b64 exec, 1
    buffer_store_dword v4, v3, s[60:63], 0 offen sc0 sc1
K1_END:
    s_endpgm
.globl k_edge_kernel
.p2align 8
.type k_edge_kernel,@function
k_edge_kernel:
    s_cmp_ge_u32 s2, 250
    s_cbranch_scc1 K2_END
    s_load_dwordx2 s[4:5], s[0:1], 0
    s_load_dwordx2 s[6:7], s[0:1], 56
    s_load_dwordx2 s[8:9], s[0:1], 64
    s_load_dwordx2 s[10:11], s[0:1], 80
    v_lshrrev_b32 v3, 6, v0
    v_and_b32 v1, 63, v0
    v_lshlrev_b32 v2, 3, v1
    v_readfirstlane_b32 s64, v3
    s_mul_i32 s66, s2, 40
    s_mov_b32 s78, 0xffff0000
    v_mov_b32 v3, 0
    v_cmp_eq_u32 vcc, 49, v0
    s_nop 1
    v_cndmask_b32 v3, v3, 16, vcc
    v_lshlrev_b32 v110, 2, v0
    v_cmp_gt_u32 vcc, 64, v0
    s_and_saveexec_b64 s[76:77], vcc
    ds_write_b32 v110, v3 offset:4096
    s_mov_b64 exec, s[76:77]
    s_waitcnt lgkmcnt(0)
    s_barrier
    s_mov_b32 s24, s4
    s_and_b32 s25, s5, 0xffff
    s_mov_b32 s26, 20480000
    s_mov_b32 s27, 0x20000
    s_mov_b32 s48, s6
    s_and_b32 s49, s7, 0xffff
    s_mov_b32 s50, 6144
    s_mov_b32 s51, 0x20000
    s_mov_b32 s32, s8
    s_and_b32 s33, s9, 0xffff
    s_mov_b32 s34, 20480000
    s_mov_b32 s35, 0x20000
    s_add_u32 s28, s10, 0
    s_addc_u32 s29, s11, 0
    s_and_b32 s29, s29, 0xffff
    s_mov_b32 s30, 15360000
    s_mov_b32 s31, 0x20000
    s_add_u32 s36, s10, 16777216
    s_addc_u32 s37, s11, 0
    s_and_b32 s37, s37, 0xffff
    s_mov_b32 s38, 5120000
    s_mov_b32 s39, 0x20000
    s_add_u32 s40, s10, 23068672
    s_addc_u32 s41, s11, 0
    s_and_b32 s41, s41, 0xffff
    s_mov_b32 s42, 160000
    s_mov_b32 s43, 0x20000
    s_add_u32 s44, s10, 24117248
    s_addc_u32 s45, s11, 0
    s_and_b32 s45, s45, 0xffff
    s_mov_b32 s46, 1000
    s_mov_b32 s47, 0x20000
    v_add_u32 v3, 0, v0
    v_lshrrev_b32 v52, 3, v3
    v_and_b32 v3, 7, v3
    v_lshlrev_b32 v3, 4, v3
    v_mul_u32_u24 v54, 640, v52
    v_add_u32 v54, v54, v3
    v_lshlrev_b32 v110, 2, v52
    buffer_load_dword v56, v110, s[44:47], 0 offen
    buffer_load_dwordx4 v[44:47], v54, s[40:43], 0 offen
    v_mov_b32 v58, v3
    v_add_u32 v3, 1024, v0
    v_lshrrev_b32 v53, 3, v3
    v_and_b32 v3, 7, v3
    v_lshlrev_b32 v3, 4, v3
    v_mul_u32_u24 v55, 640, v53
    v_add_u32 v55, v55, v3
    v_lshlrev_b32 v110, 2, v53
    buffer_load_dword v57, v110, s[44:47], 0 offen
    buffer_load_dwordx4 v[48:51], v55, s[40:43], 0 offen
    v_mov_b32 v59, v3
    s_cmp_lg_u32 s64, 15
    s_cbranch_scc1 K2_NOW
    buffer_load_dwordx2 v[60:61], v2, s[48:51], 0 offen offset:0
    buffer_load_dwordx2 v[62:63], v2, s[48:51], 0 offen offset:512
    buffer_load_dwordx2 v[64:65], v2, s[48:51], 0 offen offset:1024
    s_mov_b32 s67, 1536
    buffer_load_dwordx2 v[66:67], v2, s[48:51], s67 offen offset:0
    buffer_load_dwordx2 v[68:69], v2, s[48:51], s67 offen offset:512
    buffer_load_dwordx2 v[70:71], v2, s[48:51], s67 offen offset:1024
    s_mov_b32 s67, 3072
    buffer_load_dwordx2 v[72:73], v2, s[48:51], s67 offen offset:0
    buffer_load_dwordx2 v[74:75], v2, s[48:51], s67 offen offset:512
    buffer_load_dwordx2 v[76:77], v2, s[48:51], s67 offen offset:1024
    s_mov_b32 s67, 4608
    buffer_load_dwordx2 v[78:79], v2, s[48:51], s67 offen offset:0
    buffer_load_dwordx2 v[80:81], v2, s[48:51], s67 offen offset:512
    buffer_load_dwordx2 v[82:83], v2, s[48:51], s67 offen offset:1024
    s_mov_b32 s67, 6144
    s_waitcnt vmcnt(0)
    s_mov_b32 s12, 0x05040100
    s_mov_b32 s13, 0x07060302
    v_perm_b32 v4, v66, v60, s12
    v_perm_b32 v5, v78, v72, s12
    v_perm_b32 v6, v66, v60, s13
    v_perm_b32 v7, v78, v72, s13
    v_perm_b32 v8, v67, v61, s12
    v_perm_b32 v9, v79, v73, s12
    v_perm_b32 v10, v67, v61, s13
    v_perm_b32 v11, v79, v73, s13
    v_perm_b32 v12, v68, v62, s12
    v_perm_b32 v13, v80, v74, s12
    v_perm_b32 v14, v68, v62, s13
    v_perm_b32 v15, v80, v74, s13
    v_perm_b32 v16, v69, v63, s12
    v_perm_b32 v17, v81, v75, s12
    v_perm_b32 v18, v69, v63, s13
    v_perm_b32 v19, v81, v75, s13
    v_perm_b32 v20, v70, v64, s12
    v_perm_b32 v21, v82, v76, s12
    v_perm_b32 v22, v70, v64, s13
    v_perm_b32 v23, v82, v76, s13
    v_perm_b32 v24, v71, v65, s12
    v_perm_b32 v25, v83, v77, s12
    v_perm_b32 v26, v71, v65, s13
    v_perm_b32 v27, v83, v77, s13
    v_lshlrev_b32 v3, 4, v1
    ds_write_b128 v3, v[4:7] offset:5120
    ds_write_b128 v3, v[8:11] offset:6144
    ds_write_b128 v3, v[12:15] offset:7168
    ds_write_b128 v3, v[16:19] offset:8192
    ds_write_b128 v3, v[20:23] offset:9216
    ds_write_b128 v3, v[24:27] offset:10240
K2_NOW:
    s_mul_i32 s67, s2, 0x01010101
    s_mov_b32 s68, 0x7f7f7f7f
    s_mov_b32 s69, 0x80808080
    s_waitcnt vmcnt(0)
    v_min_u32 v56, 640, v56
    v_min_u32 v57, 640, v57
    v_xor_b32 v44, s67, v44
    v_xor_b32 v45, s67, v45
    v_xor_b32 v46, s67, v46
    v_xor_b32 v47, s67, v47
    v_and_b32 v102, s68, v44
    v_and_b32 v103, s68, v45
    v_and_b32 v104, s68, v46
    v_and_b32 v105, s68, v47
    v_add_u32 v102, s68, v102
    v_add_u32 v103, s68, v103
    v_add_u32 v104, s68, v104
    v_add_u32 v105, s68, v105
    v_or_b32 v102, v102, v44
    v_or_b32 v103, v103, v45
    v_or_b32 v104, v104, v46
    v_or_b32 v105, v105, v47
    v_not_b32 v102, v102
    v_and_b32 v102, s69, v102
    v_not_b32 v103, v103
    v_and_b32 v103, s69, v103
    v_not_b32 v104, v104
    v_and_b32 v104, s69, v104
    v_not_b32 v105, v105
    v_and_b32 v105, s69, v105
    v_lshrrev_b32 v102, 7, v102
    v_lshrrev_b32 v103, 6, v103
    v_or_b32 v102, v102, v103
    v_lshrrev_b32 v104, 5, v104
    v_or_b32 v102, v102, v104
    v_lshrrev_b32 v105, 4, v105
    v_or_b32 v102, v102, v105
    v_mov_b32 v110, 4288
    v_mov_b32 v111, 1
K2_M0_LOOP:
    v_cmp_ne_u32 vcc, 0, v102
    s_and_saveexec_b64 s[76:77], vcc
    s_cbranch_execz K2_M0_DONE
    v_ffbl_b32 v103, v102
    v_add_u32 v104, -1, v102
    v_and_b32 v102, v102, v104
    v_and_b32 v104, 7, v103
    v_lshrrev_b32 v103, 3, v103
    v_lshl_add_u32 v103, v104, 2, v103
    v_add_u32 v104, v103, v58
    v_add_u32 v103, v103, v54
    v_cmp_lt_u32 vcc, v104, v56
    s_and_b64 exec, exec, vcc
    s_cbranch_execz K2_M0_SKIP
    ds_add_rtn_u32 v105, v110, v111
    s_waitcnt lgkmcnt(0)
    v_cmp_gt_u32 vcc, 1024, v105
    s_and_b64 exec, exec, vcc
    v_lshlrev_b32 v105, 2, v105
    ds_write_b32 v105, v103 offset:0
K2_M0_SKIP:
    s_mov_b64 exec, s[76:77]
    s_branch K2_M0_LOOP
K2_M0_DONE:
    s_mov_b64 exec, s[76:77]
    v_xor_b32 v48, s67, v48
    v_xor_b32 v49, s67, v49
    v_xor_b32 v50, s67, v50
    v_xor_b32 v51, s67, v51
    v_and_b32 v102, s68, v48
    v_and_b32 v103, s68, v49
    v_and_b32 v104, s68, v50
    v_and_b32 v105, s68, v51
    v_add_u32 v102, s68, v102
    v_add_u32 v103, s68, v103
    v_add_u32 v104, s68, v104
    v_add_u32 v105, s68, v105
    v_or_b32 v102, v102, v48
    v_or_b32 v103, v103, v49
    v_or_b32 v104, v104, v50
    v_or_b32 v105, v105, v51
    v_not_b32 v102, v102
    v_and_b32 v102, s69, v102
    v_not_b32 v103, v103
    v_and_b32 v103, s69, v103
    v_not_b32 v104, v104
    v_and_b32 v104, s69, v104
    v_not_b32 v105, v105
    v_and_b32 v105, s69, v105
    v_lshrrev_b32 v102, 7, v102
    v_lshrrev_b32 v103, 6, v103
    v_or_b32 v102, v102, v103
    v_lshrrev_b32 v104, 5, v104
    v_or_b32 v102, v102, v104
    v_lshrrev_b32 v105, 4, v105
    v_or_b32 v102, v102, v105
    v_mov_b32 v110, 4288
    v_mov_b32 v111, 1
K2_M1_LOOP:
    v_cmp_ne_u32 vcc, 0, v102
    s_and_saveexec_b64 s[76:77], vcc
    s_cbranch_execz K2_M1_DONE
    v_ffbl_b32 v103, v102
    v_add_u32 v104, -1, v102
    v_and_b32 v102, v102, v104
    v_and_b32 v104, 7, v103
    v_lshrrev_b32 v103, 3, v103
    v_lshl_add_u32 v103, v104, 2, v103
    v_add_u32 v104, v103, v59
    v_add_u32 v103, v103, v55
    v_cmp_lt_u32 vcc, v104, v57
    s_and_b64 exec, exec, vcc
    s_cbranch_execz K2_M1_SKIP
    ds_add_rtn_u32 v105, v110, v111
    s_waitcnt lgkmcnt(0)
    v_cmp_gt_u32 vcc, 1024, v105
    s_and_b64 exec, exec, vcc
    v_lshlrev_b32 v105, 2, v105
    ds_write_b32 v105, v103 offset:0
K2_M1_SKIP:
    s_mov_b64 exec, s[76:77]
    s_branch K2_M1_LOOP
K2_M1_DONE:
    s_mov_b64 exec, s[76:77]
K2_ROUND:
    v_add_u32 v58, 128, v58
    v_add_u32 v54, 128, v54
    v_add_u32 v59, 128, v59
    v_add_u32 v55, 128, v55
    v_and_b32 v3, -128, v58
    v_cmp_lt_u32 s[76:77], v3, v56
    v_and_b32 v3, -128, v59
    v_cmp_lt_u32 vcc, v3, v57
    s_nop 1
    s_or_b64 vcc, vcc, s[76:77]
    s_cbranch_vccz K2_SCANNED
    buffer_load_dwordx4 v[44:47], v54, s[40:43], 0 offen
    buffer_load_dwordx4 v[48:51], v55, s[40:43], 0 offen
    s_waitcnt vmcnt(0)
    v_xor_b32 v44, s67, v44
    v_xor_b32 v45, s67, v45
    v_xor_b32 v46, s67, v46
    v_xor_b32 v47, s67, v47
    v_and_b32 v102, s68, v44
    v_and_b32 v103, s68, v45
    v_and_b32 v104, s68, v46
    v_and_b32 v105, s68, v47
    v_add_u32 v102, s68, v102
    v_add_u32 v103, s68, v103
    v_add_u32 v104, s68, v104
    v_add_u32 v105, s68, v105
    v_or_b32 v102, v102, v44
    v_or_b32 v103, v103, v45
    v_or_b32 v104, v104, v46
    v_or_b32 v105, v105, v47
    v_not_b32 v102, v102
    v_and_b32 v102, s69, v102
    v_not_b32 v103, v103
    v_and_b32 v103, s69, v103
    v_not_b32 v104, v104
    v_and_b32 v104, s69, v104
    v_not_b32 v105, v105
    v_and_b32 v105, s69, v105
    v_lshrrev_b32 v102, 7, v102
    v_lshrrev_b32 v103, 6, v103
    v_or_b32 v102, v102, v103
    v_lshrrev_b32 v104, 5, v104
    v_or_b32 v102, v102, v104
    v_lshrrev_b32 v105, 4, v105
    v_or_b32 v102, v102, v105
    v_mov_b32 v110, 4288
    v_mov_b32 v111, 1
K2_R0_LOOP:
    v_cmp_ne_u32 vcc, 0, v102
    s_and_saveexec_b64 s[76:77], vcc
    s_cbranch_execz K2_R0_DONE
    v_ffbl_b32 v103, v102
    v_add_u32 v104, -1, v102
    v_and_b32 v102, v102, v104
    v_and_b32 v104, 7, v103
    v_lshrrev_b32 v103, 3, v103
    v_lshl_add_u32 v103, v104, 2, v103
    v_add_u32 v104, v103, v58
    v_add_u32 v103, v103, v54
    v_cmp_lt_u32 vcc, v104, v56
    s_and_b64 exec, exec, vcc
    s_cbranch_execz K2_R0_SKIP
    ds_add_rtn_u32 v105, v110, v111
    s_waitcnt lgkmcnt(0)
    v_cmp_gt_u32 vcc, 1024, v105
    s_and_b64 exec, exec, vcc
    v_lshlrev_b32 v105, 2, v105
    ds_write_b32 v105, v103 offset:0
K2_R0_SKIP:
    s_mov_b64 exec, s[76:77]
    s_branch K2_R0_LOOP
K2_R0_DONE:
    s_mov_b64 exec, s[76:77]
    v_xor_b32 v48, s67, v48
    v_xor_b32 v49, s67, v49
    v_xor_b32 v50, s67, v50
    v_xor_b32 v51, s67, v51
    v_and_b32 v102, s68, v48
    v_and_b32 v103, s68, v49
    v_and_b32 v104, s68, v50
    v_and_b32 v105, s68, v51
    v_add_u32 v102, s68, v102
    v_add_u32 v103, s68, v103
    v_add_u32 v104, s68, v104
    v_add_u32 v105, s68, v105
    v_or_b32 v102, v102, v48
    v_or_b32 v103, v103, v49
    v_or_b32 v104, v104, v50
    v_or_b32 v105, v105, v51
    v_not_b32 v102, v102
    v_and_b32 v102, s69, v102
    v_not_b32 v103, v103
    v_and_b32 v103, s69, v103
    v_not_b32 v104, v104
    v_and_b32 v104, s69, v104
    v_not_b32 v105, v105
    v_and_b32 v105, s69, v105
    v_lshrrev_b32 v102, 7, v102
    v_lshrrev_b32 v103, 6, v103
    v_or_b32 v102, v102, v103
    v_lshrrev_b32 v104, 5, v104
    v_or_b32 v102, v102, v104
    v_lshrrev_b32 v105, 4, v105
    v_or_b32 v102, v102, v105
    v_mov_b32 v110, 4288
    v_mov_b32 v111, 1
K2_R1_LOOP:
    v_cmp_ne_u32 vcc, 0, v102
    s_and_saveexec_b64 s[76:77], vcc
    s_cbranch_execz K2_R1_DONE
    v_ffbl_b32 v103, v102
    v_add_u32 v104, -1, v102
    v_and_b32 v102, v102, v104
    v_and_b32 v104, 7, v103
    v_lshrrev_b32 v103, 3, v103
    v_lshl_add_u32 v103, v104, 2, v103
    v_add_u32 v104, v103, v59
    v_add_u32 v103, v103, v55
    v_cmp_lt_u32 vcc, v104, v57
    s_and_b64 exec, exec, vcc
    s_cbranch_execz K2_R1_SKIP
    ds_add_rtn_u32 v105, v110, v111
    s_waitcnt lgkmcnt(0)
    v_cmp_gt_u32 vcc, 1024, v105
    s_and_b64 exec, exec, vcc
    v_lshlrev_b32 v105, 2, v105
    ds_write_b32 v105, v103 offset:0
K2_R1_SKIP:
    s_mov_b64 exec, s[76:77]
    s_branch K2_R1_LOOP
K2_R1_DONE:
    s_mov_b64 exec, s[76:77]
    s_branch K2_ROUND
K2_SCANNED:
    s_waitcnt lgkmcnt(0)
    s_barrier
    v_lshlrev_b32 v3, 4, v1
    ds_read_b128 v[4:7], v3 offset:5120
    ds_read_b128 v[8:11], v3 offset:6144
    ds_read_b128 v[12:15], v3 offset:7168
    ds_read_b128 v[16:19], v3 offset:8192
    ds_read_b128 v[20:23], v3 offset:9216
    ds_read_b128 v[24:27], v3 offset:10240
    v_mov_b32 v3, 4288
    ds_read_b32 v86, v3
    v_lshlrev_b32 v87, 2, v0
    ds_read_b32 v87, v87 offset:0
    s_waitcnt lgkmcnt(0)
    v_readfirstlane_b32 s71, v86
    v_cmp_gt_u32 vcc, s71, v0
    s_and_saveexec_b64 s[76:77], vcc
    s_cbranch_execz K2_NOREC
    v_lshlrev_b32 v87, 5, v87
    buffer_load_dwordx4 v[44:47], v87, s[36:39], 0 offen
    buffer_load_dwordx4 v[48:51], v87, s[36:39], 0 offen offset:16
K2_NOREC:
    s_mov_b64 exec, s[76:77]
    v_lshlrev_b32 v3, 4, v0
    s_lshl_b32 s75, s66, 11
    s_add_u32 s75, s75, 0
    buffer_load_dwordx4 v[102:105], v3, s[24:27], s75 offen
    s_add_u32 s75, s75, 16384
    buffer_load_dwordx4 v[106:109], v3, s[24:27], s75 offen
    s_add_u32 s75, s75, 16384
    buffer_load_dwordx4 v[110:113], v3, s[24:27], s75 offen
    s_add_u32 s75, s75, 16384
    buffer_load_dwordx4 v[114:117], v3, s[24:27], s75 offen
    s_add_u32 s75, s75, 16384
    buffer_load_dwordx4 v[118:121], v3, s[24:27], s75 offen
    s_add_u32 s75, s75, 16384
    s_cmp_gt_u32 s71, 1024
    s_cbranch_scc1 K2_SETOV
    v_cmp_gt_u32 vcc, s71, v0
    s_and_saveexec_b64 s[76:77], vcc
    s_cbranch_execz K2_BDONE
    v_mov_b32 v90, 1
    s_waitcnt vmcnt(5)
    v_subrev_u32 v87, s66, v45
    v_lshlrev_b32 v88, 2, v87
    ds_add_rtn_u32 v90, v88, v90 offset:4096
    s_waitcnt lgkmcnt(0)
    v_cmp_le_u32 vcc, 32, v90
    s_cbranch_vccz K2_NOOV
    v_mov_b32 v88, 4288
    v_mov_b32 v89, 1
    ds_write_b32 v88, v89 offset:8
K2_NOOV:
    v_cmp_gt_u32 vcc, 32, v90
    s_and_b64 exec, exec, vcc
    s_cbranch_execz K2_BDONE
    v_lshl_add_u32 v87, v87, 5, v90
    v_lshlrev_b32 v87, 5, v87
    ds_write_b128 v87, v[44:47] offset:11264
    ds_write_b128 v87, v[48:51] offset:11280
    s_branch K2_BDONE
K2_SETOV:
    s_mov_b64 s[76:77], exec
    v_mov_b32 v88, 4288
    v_mov_b32 v89, 1
    ds_write_b32 v88, v89 offset:8
K2_BDONE:
    s_mov_b64 exec, s[76:77]
    s_waitcnt lgkmcnt(0)
    s_barrier
    v_mov_b32 v3, 4288
    ds_read_b32 v86, v3 offset:8
    s_waitcnt lgkmcnt(0)
    v_readfirstlane_b32 s67, v86
    s_cmp_lg_u32 s67, 0
    s_cbranch_scc1 K2_SLOW0
    v_lshlrev_b32 v125, 2, v1
    ds_read_b32 v125, v125 offset:4096
    v_mov_b32 v126, v1
    v_cmp_gt_u32 vcc, 40, v1
    s_mov_b64 s[80:81], 0
    s_waitcnt lgkmcnt(0)
    v_cndmask_b32 v125, -1, v125, vcc
    v_cmp_le_i32 s[82:83], 8, v125
    s_bcnt1_i32_b64 s86, s[80:81]
    s_andn2_b64 s[84:85], s[82:83], s[80:81]
    v_mbcnt_lo_u32_b32 v127, s84, 0
    v_mbcnt_hi_u32_b32 v127, s85, v127
    v_add_u32 v127, s86, v127
    v_cndmask_b32 v126, v126, v127, s[84:85]
    s_mov_b64 s[80:81], s[82:83]
    v_cmp_le_i32 s[82:83], 6, v125
    s_bcnt1_i32_b64 s86, s[80:81]
    s_andn2_b64 s[84:85], s[82:83], s[80:81]
    v_mbcnt_lo_u32_b32 v127, s84, 0
    v_mbcnt_hi_u32_b32 v127, s85, v127
    v_add_u32 v127, s86, v127
    v_cndmask_b32 v126, v126, v127, s[84:85]
    s_mov_b64 s[80:81], s[82:83]
    v_cmp_le_i32 s[82:83], 5, v125
    s_bcnt1_i32_b64 s86, s[80:81]
    s_andn2_b64 s[84:85], s[82:83], s[80:81]
    v_mbcnt_lo_u32_b32 v127, s84, 0
    v_mbcnt_hi_u32_b32 v127, s85, v127
    v_add_u32 v127, s86, v127
    v_cndmask_b32 v126, v126, v127, s[84:85]
    s_mov_b64 s[80:81], s[82:83]
    v_cmp_le_i32 s[82:83], 4, v125
    s_bcnt1_i32_b64 s86, s[80:81]
    s_andn2_b64 s[84:85], s[82:83], s[80:81]
    v_mbcnt_lo_u32_b32 v127, s84, 0
    v_mbcnt_hi_u32_b32 v127, s85, v127
    v_add_u32 v127, s86, v127
    v_cndmask_b32 v126, v126, v127, s[84:85]
    s_mov_b64 s[80:81], s[82:83]
    v_cmp_le_i32 s[82:83], 3, v125
    s_bcnt1_i32_b64 s86, s[80:81]
    s_andn2_b64 s[84:85], s[82:83], s[80:81]
    v_mbcnt_lo_u32_b32 v127, s84, 0
    v_mbcnt_hi_u32_b32 v127, s85, v127
    v_add_u32 v127, s86, v127
    v_cndmask_b32 v126, v126, v127, s[84:85]
    s_mov_b64 s[80:81], s[82:83]
    v_cmp_le_i32 s[82:83], 2, v125
    s_bcnt1_i32_b64 s86, s[80:81]
    s_andn2_b64 s[84:85], s[82:83], s[80:81]
    v_mbcnt_lo_u32_b32 v127, s84, 0
    v_mbcnt_hi_u32_b32 v127, s85, v127
    v_add_u32 v127, s86, v127
    v_cndmask_b32 v126, v126, v127, s[84:85]
    s_mov_b64 s[80:81], s[82:83]
    v_cmp_le_i32 s[82:83], 1, v125
    s_bcnt1_i32_b64 s86, s[80:81]
    s_andn2_b64 s[84:85], s[82:83], s[80:81]
    v_mbcnt_lo_u32_b32 v127, s84, 0
    v_mbcnt_hi_u32_b32 v127, s85, v127
    v_add_u32 v127, s86, v127
    v_cndmask_b32 v126, v126, v127, s[84:85]
    s_mov_b64 s[80:81], s[82:83]
    v_cmp_le_i32 s[82:83], 0, v125
    s_bcnt1_i32_b64 s86, s[80:81]
    s_andn2_b64 s[84:85], s[82:83], s[80:81]
    v_mbcnt_lo_u32_b32 v127, s84, 0
    v_mbcnt_hi_u32_b32 v127, s85, v127
    v_add_u32 v127, s86, v127
    v_cndmask_b32 v126, v126, v127, s[84:85]
    s_mov_b64 s[80:81], s[82:83]
    v_lshlrev_b32 v126, 2, v126
    ds_permute_b32 v124, v126, v1
    s_mov_b32 s92, 0
    s_waitcnt lgkmcnt(0)
    v_readlane_b32 s88, v124, s64
    s_lshl_b32 s67, s88, 2
    v_mov_b32 v122, s67
    ds_read_b32 v123, v122 offset:4096
    s_lshl_b32 s91, s88, 10
    s_add_u32 s91, s91, 11264
    v_and_b32 v122, 31, v1
    v_lshlrev_b32 v122, 5, v122
    v_add_u32 v122, s91, v122
    ds_read_b32 v3, v122
    s_mov_b32 s90, 0
    s_waitcnt lgkmcnt(0)
    v_readfirstlane_b32 s89, v123
    s_mov_b32 s80, s88
    s_mov_b32 s82, 0
    s_mov_b32 s83, 0
    s_cmp_ge_u32 s88, 40
    s_cbranch_scc1 K2_P0_DONE
    s_mov_b32 s81, s91
    s_min_u32 s82, s89, 2
    s_cmp_le_u32 s82, 0
    s_cbranch_scc1 K2_P0_ISSUED
    v_readlane_b32 s67, v3, s90
    s_add_u32 s90, s90, 1
    s_mul_i32 s73, s67, 1536
    s_lshl_b32 s74, s67, 11
    buffer_load_dwordx2 v[44:45], v2, s[28:31], s73 offen offset:0
    buffer_load_dwordx2 v[46:47], v2, s[28:31], s73 offen offset:512
    buffer_load_dwordx2 v[48:49], v2, s[28:31], s73 offen offset:1024
    buffer_load_dwordx2 v[50:51], v2, s[24:27], s74 offen offset:512
    buffer_load_dwordx2 v[52:53], v2, s[24:27], s74 offen offset:1024
    buffer_load_dwordx2 v[54:55], v2, s[24:27], s74 offen offset:1536
    s_cmp_le_u32 s82, 1
    s_cbranch_scc1 K2_P0_ISSUED
    v_readlane_b32 s67, v3, s90
    s_add_u32 s90, s90, 1
    s_mul_i32 s73, s67, 1536
    s_lshl_b32 s74, s67, 11
    buffer_load_dwordx2 v[56:57], v2, s[28:31], s73 offen offset:0
    buffer_load_dwordx2 v[58:59], v2, s[28:31], s73 offen offset:512
    buffer_load_dwordx2 v[60:61], v2, s[28:31], s73 offen offset:1024
    buffer_load_dwordx2 v[62:63], v2, s[24:27], s74 offen offset:512
    buffer_load_dwordx2 v[64:65], v2, s[24:27], s74 offen offset:1024
    buffer_load_dwordx2 v[66:67], v2, s[24:27], s74 offen offset:1536
K2_P0_ISSUED:
    s_add_u32 s91, s91, 64
    s_sub_u32 s89, s89, s82
    s_cmp_lg_u32 s89, 0
    s_cbranch_scc1 K2_P0_DONE
    s_mov_b32 s83, 1
    v_mov_b32 v122, 4288
    v_mov_b32 v123, 1
    s_mov_b64 exec, 1
    ds_add_rtn_u32 v123, v122, v123 offset:4
    s_waitcnt lgkmcnt(0)
    s_mov_b64 exec, -1
    v_readfirstlane_b32 s88, v123
    s_cmp_ge_u32 s88, 40
    s_cbranch_scc1 K2_P0_DONE
    s_nop 3
    v_readlane_b32 s88, v124, s88
    s_lshl_b32 s67, s88, 2
    v_mov_b32 v122, s67
    ds_read_b32 v123, v122 offset:4096
    s_lshl_b32 s91, s88, 10
    s_add_u32 s91, s91, 11264
    v_and_b32 v122, 31, v1
    v_lshlrev_b32 v122, 5, v122
    v_add_u32 v122, s91, v122
    ds_read_b32 v3, v122
    s_mov_b32 s90, 0
    s_waitcnt lgkmcnt(0)
    v_readfirstlane_b32 s89, v123
K2_P0_DONE:
    s_mov_b32 s84, s88
    s_mov_b32 s86, 0
    s_mov_b32 s87, 0
    s_cmp_ge_u32 s88, 40
    s_cbranch_scc1 K2_P1_DONE
    s_mov_b32 s85, s91
    s_min_u32 s86, s89, 2
    s_cmp_le_u32 s86, 0
    s_cbranch_scc1 K2_P1_ISSUED
    v_readlane_b32 s67, v3, s90
    s_add_u32 s90, s90, 1
    s_mul_i32 s73, s67, 1536
    s_lshl_b32 s74, s67, 11
    buffer_load_dwordx2 v[68:69], v2, s[28:31], s73 offen offset:0
    buffer_load_dwordx2 v[70:71], v2, s[28:31], s73 offen offset:512
    buffer_load_dwordx2 v[72:73], v2, s[28:31], s73 offen offset:1024
    buffer_load_dwordx2 v[74:75], v2, s[24:27], s74 offen offset:512
    buffer_load_dwordx2 v[76:77], v2, s[24:27], s74 offen offset:1024
    buffer_load_dwordx2 v[78:79], v2, s[24:27], s74 offen offset:1536
    s_cmp_le_u32 s86, 1
    s_cbranch_scc1 K2_P1_ISSUED
    v_readlane_b32 s67, v3, s90
    s_add_u32 s90, s90, 1
    s_mul_i32 s73, s67, 1536
    s_lshl_b32 s74, s67, 11
    buffer_load_dwordx2 v[80:81], v2, s[28:31], s73 offen offset:0
    buffer_load_dwordx2 v[82:83], v2, s[28:31], s73 offen offset:512
    buffer_load_dwordx2 v[84:85], v2, s[28:31], s73 offen offset:1024
    buffer_load_dwordx2 v[86:87], v2, s[24:27], s74 offen offset:512
    buffer_load_dwordx2 v[88:89], v2, s[24:27], s74 offen offset:1024
    buffer_load_dwordx2 v[90:91], v2, s[24:27], s74 offen offset:1536
K2_P1_ISSUED:
    s_add_u32 s91, s91, 64
    s_sub_u32 s89, s89, s86
    s_cmp_lg_u32 s89, 0
    s_cbranch_scc1 K2_P1_DONE
    s_mov_b32 s87, 1
    v_mov_b32 v122, 4288
    v_mov_b32 v123, 1
    s_mov_b64 exec, 1
    ds_add_rtn_u32 v123, v122, v123 offset:4
    s_waitcnt lgkmcnt(0)
    s_mov_b64 exec, -1
    v_readfirstlane_b32 s88, v123
    s_cmp_ge_u32 s88, 40
    s_cbranch_scc1 K2_P1_DONE
    s_nop 3
    v_readlane_b32 s88, v124, s88
    s_lshl_b32 s67, s88, 2
    v_mov_b32 v122, s67
    ds_read_b32 v123, v122 offset:4096
    s_lshl_b32 s91, s88, 10
    s_add_u32 s91, s91, 11264
    v_and_b32 v122, 31, v1
    v_lshlrev_b32 v122, 5, v122
    v_add_u32 v122, s91, v122
    ds_read_b32 v3, v122
    s_mov_b32 s90, 0
    s_waitcnt lgkmcnt(0)
    v_readfirstlane_b32 s89, v123
K2_P1_DONE:
    s_add_u32 s67, s82, s86
    s_cmp_eq_u32 s67, 4
    s_cbranch_scc1 K2_RW4
    s_cmp_eq_u32 s67, 3
    s_cbranch_scc1 K2_RW3
    s_cmp_eq_u32 s67, 2
    s_cbranch_scc1 K2_RW2
    s_cmp_eq_u32 s67, 1
    s_cbranch_scc1 K2_RW1
    s_waitcnt vmcnt(0)
    s_branch K2_RWD
K2_RW4:
    s_waitcnt vmcnt(24)
    s_branch K2_RWD
K2_RW3:
    s_waitcnt vmcnt(18)
    s_branch K2_RWD
K2_RW2:
    s_waitcnt vmcnt(12)
    s_branch K2_RWD
K2_RW1:
    s_waitcnt vmcnt(6)
K2_RWD:
    v_lshlrev_b32 v122, 4, v0
    v_add_u32 v123, 117760, v122
    v_add_u32 v122, 52224, v122
    ds_write_b128 v122, v[102:105] offset:0
    ds_write_b128 v122, v[106:109] offset:16384
    ds_write_b128 v122, v[110:113] offset:32768
    ds_write_b128 v122, v[114:117] offset:49152
    ds_write_b128 v123, v[118:121]
    s_waitcnt lgkmcnt(0)
    s_barrier
    v_mov_b32 v28, 0
    v_mov_b32 v29, 0
    v_mov_b32 v30, 0
    v_mov_b32 v31, 0
    v_mov_b32 v32, 0
    v_mov_b32 v33, 0
    v_mov_b32 v34, 0
    v_mov_b32 v35, 0
    v_mov_b32 v36, 0
    v_mov_b32 v37, 0
    v_mov_b32 v38, 0
    v_mov_b32 v39, 0
    v_mov_b32 v40, 0
    v_mov_b32 v41, 0
    v_mov_b32 v42, 0
    v_mov_b32 v43, 0
K2_LOOP:
    s_cmp_ge_u32 s80, 40
    s_cbranch_scc1 K2_END
    s_cmp_eq_u32 s82, 0
    s_cbranch_scc1 K2_S0_C0
    v_and_b32 v122, 3, v1
    v_lshlrev_b32 v122, 5, v122
    v_add_u32 v122, s81, v122
    ds_read_b64 v[92:93], v122 offset:8
    v_mov_b32 v123, s81
    ds_read_b128 v[94:97], v123 offset:16
    ds_read_b128 v[98:101], v123 offset:48
    s_mul_i32 s67, s86, 6
    s_lshl_b32 s68, s92, 2
    s_add_u32 s67, s67, s68
    s_cmp_eq_u32 s67, 16
    s_cbranch_scc1 K2_S0_W16
    s_cmp_eq_u32 s67, 12
    s_cbranch_scc1 K2_S0_W12
    s_cmp_eq_u32 s67, 10
    s_cbranch_scc1 K2_S0_W10
    s_cmp_eq_u32 s67, 6
    s_cbranch_scc1 K2_S0_W6
    s_cmp_eq_u32 s67, 4
    s_cbranch_scc1 K2_S0_W4
    s_waitcnt vmcnt(0)
    s_branch K2_S0_WD
K2_S0_W16:
    s_waitcnt vmcnt(16)
    s_branch K2_S0_WD
K2_S0_W12:
    s_waitcnt vmcnt(12)
    s_branch K2_S0_WD
K2_S0_W10:
    s_waitcnt vmcnt(10)
    s_branch K2_S0_WD
K2_S0_W6:
    s_waitcnt vmcnt(6)
    s_branch K2_S0_WD
K2_S0_W4:
    s_waitcnt vmcnt(4)
K2_S0_WD:
    s_waitcnt lgkmcnt(0)
    s_cmp_eq_u32 s82, 1
    s_cbranch_scc1 K2_S0_C1
    v_mfma_f32_4x4x4_16b_bf16 v[102:105], v[92:93], v[4:5], 0
    v_mfma_f32_4x4x4_16b_bf16 v[106:109], v[92:93], v[6:7], 0
    v_mfma_f32_4x4x4_16b_bf16 v[110:113], v[92:93], v[8:9], 0
    v_mfma_f32_4x4x4_16b_bf16 v[114:117], v[92:93], v[10:11], 0
    v_lshlrev_b32 v118, 16, v44
    v_and_b32 v119, s78, v44
    v_lshlrev_b32 v120, 16, v45
    v_and_b32 v121, s78, v45
    s_nop 1
    v_mul_f32 v118, v102, v118
    v_mul_f32 v119, v106, v119
    v_mul_f32 v120, v110, v120
    v_mul_f32 v121, v114, v121
    v_fma_f32 v28, v118, v94, v28
    v_fma_f32 v29, v119, v94, v29
    v_fma_f32 v30, v120, v94, v30
    v_fma_f32 v31, v121, v94, v31
    v_lshlrev_b32 v118, 16, v56
    v_and_b32 v119, s78, v56
    v_lshlrev_b32 v120, 16, v57
    v_and_b32 v121, s78, v57
    v_mul_f32 v118, v103, v118
    v_mul_f32 v119, v107, v119
    v_mul_f32 v120, v111, v120
    v_mul_f32 v121, v115, v121
    v_fma_f32 v28, v118, v98, v28
    v_fma_f32 v29, v119, v98, v29
    v_fma_f32 v30, v120, v98, v30
    v_fma_f32 v31, v121, v98, v31
    v_mfma_f32_4x4x4_16b_bf16 v[102:105], v[92:93], v[12:13], 0
    v_mfma_f32_4x4x4_16b_bf16 v[106:109], v[92:93], v[14:15], 0
    v_mfma_f32_4x4x4_16b_bf16 v[110:113], v[92:93], v[16:17], 0
    v_mfma_f32_4x4x4_16b_bf16 v[114:117], v[92:93], v[18:19], 0
    v_lshlrev_b32 v118, 16, v46
    v_and_b32 v119, s78, v46
    v_lshlrev_b32 v120, 16, v47
    v_and_b32 v121, s78, v47
    s_nop 1
    v_mul_f32 v118, v102, v118
    v_mul_f32 v119, v106, v119
    v_mul_f32 v120, v110, v120
    v_mul_f32 v121, v114, v121
    v_mul_f32 v102, v118, v94
    v_mul_f32 v106, v119, v94
    v_mul_f32 v110, v120, v94
    v_mul_f32 v114, v121, v94
    v_lshlrev_b32 v118, 16, v50
    v_and_b32 v119, s78, v50
    v_lshlrev_b32 v120, 16, v51
    v_and_b32 v121, s78, v51
    v_fma_f32 v32, v102, v118, v32
    v_fma_f32 v33, v106, v119, v33
    v_fma_f32 v34, v110, v120, v34
    v_fma_f32 v35, v114, v121, v35
    v_lshlrev_b32 v118, 16, v52
    v_and_b32 v119, s78, v52
    v_lshlrev_b32 v120, 16, v53
    v_and_b32 v121, s78, v53
    v_fma_f32 v36, v102, v118, v36
    v_fma_f32 v37, v106, v119, v37
    v_fma_f32 v38, v110, v120, v38
    v_fma_f32 v39, v114, v121, v39
    v_lshlrev_b32 v118, 16, v54
    v_and_b32 v119, s78, v54
    v_lshlrev_b32 v120, 16, v55
    v_and_b32 v121, s78, v55
    v_fma_f32 v40, v102, v118, v40
    v_fma_f32 v41, v106, v119, v41
    v_fma_f32 v42, v110, v120, v42
    v_fma_f32 v43, v114, v121, v43
    v_lshlrev_b32 v118, 16, v58
    v_and_b32 v119, s78, v58
    v_lshlrev_b32 v120, 16, v59
    v_and_b32 v121, s78, v59
    v_mul_f32 v118, v103, v118
    v_mul_f32 v119, v107, v119
    v_mul_f32 v120, v111, v120
    v_mul_f32 v121, v115, v121
    v_mul_f32 v103, v118, v98
    v_mul_f32 v107, v119, v98
    v_mul_f32 v111, v120, v98
    v_mul_f32 v115, v121, v98
    v_lshlrev_b32 v118, 16, v62
    v_and_b32 v119, s78, v62
    v_lshlrev_b32 v120, 16, v63
    v_and_b32 v121, s78, v63
    v_fma_f32 v32, v103, v118, v32
    v_fma_f32 v33, v107, v119, v33
    v_fma_f32 v34, v111, v120, v34
    v_fma_f32 v35, v115, v121, v35
    v_lshlrev_b32 v118, 16, v64
    v_and_b32 v119, s78, v64
    v_lshlrev_b32 v120, 16, v65
    v_and_b32 v121, s78, v65
    v_fma_f32 v36, v103, v118, v36
    v_fma_f32 v37, v107, v119, v37
    v_fma_f32 v38, v111, v120, v38
    v_fma_f32 v39, v115, v121, v39
    v_lshlrev_b32 v118, 16, v66
    v_and_b32 v119, s78, v66
    v_lshlrev_b32 v120, 16, v67
    v_and_b32 v121, s78, v67
    v_fma_f32 v40, v103, v118, v40
    v_fma_f32 v41, v107, v119, v41
    v_fma_f32 v42, v111, v120, v42
    v_fma_f32 v43, v115, v121, v43
    v_mfma_f32_4x4x4_16b_bf16 v[102:105], v[92:93], v[20:21], 0
    v_mfma_f32_4x4x4_16b_bf16 v[106:109], v[92:93], v[22:23], 0
    v_mfma_f32_4x4x4_16b_bf16 v[110:113], v[92:93], v[24:25], 0
    v_mfma_f32_4x4x4_16b_bf16 v[114:117], v[92:93], v[26:27], 0
    v_lshlrev_b32 v118, 16, v48
    v_and_b32 v119, s78, v48
    v_lshlrev_b32 v120, 16, v49
    v_and_b32 v121, s78, v49
    s_nop 1
    v_mul_f32 v118, v102, v118
    v_mul_f32 v119, v106, v119
    v_mul_f32 v120, v110, v120
    v_mul_f32 v121, v114, v121
    v_fma_f32 v32, v118, v95, v32
    v_fma_f32 v33, v119, v95, v33
    v_fma_f32 v34, v120, v95, v34
    v_fma_f32 v35, v121, v95, v35
    v_fma_f32 v36, v118, v96, v36
    v_fma_f32 v37, v119, v96, v37
    v_fma_f32 v38, v120, v96, v38
    v_fma_f32 v39, v121, v96, v39
    v_fma_f32 v40, v118, v97, v40
    v_fma_f32 v41, v119, v97, v41
    v_fma_f32 v42, v120, v97, v42
    v_fma_f32 v43, v121, v97, v43
    v_lshlrev_b32 v118, 16, v60
    v_and_b32 v119, s78, v60
    v_lshlrev_b32 v120, 16, v61
    v_and_b32 v121, s78, v61
    v_mul_f32 v118, v103, v118
    v_mul_f32 v119, v107, v119
    v_mul_f32 v120, v111, v120
    v_mul_f32 v121, v115, v121
    v_fma_f32 v32, v118, v99, v32
    v_fma_f32 v33, v119, v99, v33
    v_fma_f32 v34, v120, v99, v34
    v_fma_f32 v35, v121, v99, v35
    v_fma_f32 v36, v118, v100, v36
    v_fma_f32 v37, v119, v100, v37
    v_fma_f32 v38, v120, v100, v38
    v_fma_f32 v39, v121, v100, v39
    v_fma_f32 v40, v118, v101, v40
    v_fma_f32 v41, v119, v101, v41
    v_fma_f32 v42, v120, v101, v42
    v_fma_f32 v43, v121, v101, v43
    s_branch K2_S0_C0
K2_S0_C1:
    v_mfma_f32_4x4x4_16b_bf16 v[102:105], v[92:93], v[4:5], 0
    v_mfma_f32_4x4x4_16b_bf16 v[106:109], v[92:93], v[6:7], 0
    v_mfma_f32_4x4x4_16b_bf16 v[110:113], v[92:93], v[8:9], 0
    v_mfma_f32_4x4x4_16b_bf16 v[114:117], v[92:93], v[10:11], 0
    v_lshlrev_b32 v118, 16, v44
    v_and_b32 v119, s78, v44
    v_lshlrev_b32 v120, 16, v45
    v_and_b32 v121, s78, v45
    s_nop 1
    v_mul_f32 v118, v102, v118
    v_mul_f32 v119, v106, v119
    v_mul_f32 v120, v110, v120
    v_mul_f32 v121, v114, v121
    v_fma_f32 v28, v118, v94, v28
    v_fma_f32 v29, v119, v94, v29
    v_fma_f32 v30, v120, v94, v30
    v_fma_f32 v31, v121, v94, v31
    v_mfma_f32_4x4x4_16b_bf16 v[102:105], v[92:93], v[12:13], 0
    v_mfma_f32_4x4x4_16b_bf16 v[106:109], v[92:93], v[14:15], 0
    v_mfma_f32_4x4x4_16b_bf16 v[110:113], v[92:93], v[16:17], 0
    v_mfma_f32_4x4x4_16b_bf16 v[114:117], v[92:93], v[18:19], 0
    v_lshlrev_b32 v118, 16, v46
    v_and_b32 v119, s78, v46
    v_lshlrev_b32 v120, 16, v47
    v_and_b32 v121, s78, v47
    s_nop 1
    v_mul_f32 v118, v102, v118
    v_mul_f32 v119, v106, v119
    v_mul_f32 v120, v110, v120
    v_mul_f32 v121, v114, v121
    v_mul_f32 v102, v118, v94
    v_mul_f32 v106, v119, v94
    v_mul_f32 v110, v120, v94
    v_mul_f32 v114, v121, v94
    v_lshlrev_b32 v118, 16, v50
    v_and_b32 v119, s78, v50
    v_lshlrev_b32 v120, 16, v51
    v_and_b32 v121, s78, v51
    v_fma_f32 v32, v102, v118, v32
    v_fma_f32 v33, v106, v119, v33
    v_fma_f32 v34, v110, v120, v34
    v_fma_f32 v35, v114, v121, v35
    v_lshlrev_b32 v118, 16, v52
    v_and_b32 v119, s78, v52
    v_lshlrev_b32 v120, 16, v53
    v_and_b32 v121, s78, v53
    v_fma_f32 v36, v102, v118, v36
    v_fma_f32 v37, v106, v119, v37
    v_fma_f32 v38, v110, v120, v38
    v_fma_f32 v39, v114, v121, v39
    v_lshlrev_b32 v118, 16, v54
    v_and_b32 v119, s78, v54
    v_lshlrev_b32 v120, 16, v55
    v_and_b32 v121, s78, v55
    v_fma_f32 v40, v102, v118, v40
    v_fma_f32 v41, v106, v119, v41
    v_fma_f32 v42, v110, v120, v42
    v_fma_f32 v43, v114, v121, v43
    v_mfma_f32_4x4x4_16b_bf16 v[102:105], v[92:93], v[20:21], 0
    v_mfma_f32_4x4x4_16b_bf16 v[106:109], v[92:93], v[22:23], 0
    v_mfma_f32_4x4x4_16b_bf16 v[110:113], v[92:93], v[24:25], 0
    v_mfma_f32_4x4x4_16b_bf16 v[114:117], v[92:93], v[26:27], 0
    v_lshlrev_b32 v118, 16, v48
    v_and_b32 v119, s78, v48
    v_lshlrev_b32 v120, 16, v49
    v_and_b32 v121, s78, v49
    s_nop 1
    v_mul_f32 v118, v102, v118
    v_mul_f32 v119, v106, v119
    v_mul_f32 v120, v110, v120
    v_mul_f32 v121, v114, v121
    v_fma_f32 v32, v118, v95, v32
    v_fma_f32 v33, v119, v95, v33
    v_fma_f32 v34, v120, v95, v34
    v_fma_f32 v35, v121, v95, v35
    v_fma_f32 v36, v118, v96, v36
    v_fma_f32 v37, v119, v96, v37
    v_fma_f32 v38, v120, v96, v38
    v_fma_f32 v39, v121, v96, v39
    v_fma_f32 v40, v118, v97, v40
    v_fma_f32 v41, v119, v97, v41
    v_fma_f32 v42, v120, v97, v42
    v_fma_f32 v43, v121, v97, v43
K2_S0_C0:
    s_mov_b32 s69, s83
    s_mov_b32 s72, s80
    s_mov_b32 s80, s88
    s_mov_b32 s82, 0
    s_mov_b32 s83, 0
    s_cmp_ge_u32 s88, 40
    s_cbranch_scc1 K2_S0_MB_DONE
    s_mov_b32 s81, s91
    s_min_u32 s82, s89, 2
    s_cmp_le_u32 s82, 0
    s_cbranch_scc1 K2_S0_MB_ISSUED
    v_readlane_b32 s67, v3, s90
    s_add_u32 s90, s90, 1
    s_mul_i32 s73, s67, 1536
    s_lshl_b32 s74, s67, 11
    buffer_load_dwordx2 v[44:45], v2, s[28:31], s73 offen offset:0
    buffer_load_dwordx2 v[46:47], v2, s[28:31], s73 offen offset:512
    buffer_load_dwordx2 v[48:49], v2, s[28:31], s73 offen offset:1024
    buffer_load_dwordx2 v[50:51], v2, s[24:27], s74 offen offset:512
    buffer_load_dwordx2 v[52:53], v2, s[24:27], s74 offen offset:1024
    buffer_load_dwordx2 v[54:55], v2, s[24:27], s74 offen offset:1536
    s_cmp_le_u32 s82, 1
    s_cbranch_scc1 K2_S0_MB_ISSUED
    v_readlane_b32 s67, v3, s90
    s_add_u32 s90, s90, 1
    s_mul_i32 s73, s67, 1536
    s_lshl_b32 s74, s67, 11
    buffer_load_dwordx2 v[56:57], v2, s[28:31], s73 offen offset:0
    buffer_load_dwordx2 v[58:59], v2, s[28:31], s73 offen offset:512
    buffer_load_dwordx2 v[60:61], v2, s[28:31], s73 offen offset:1024
    buffer_load_dwordx2 v[62:63], v2, s[24:27], s74 offen offset:512
    buffer_load_dwordx2 v[64:65], v2, s[24:27], s74 offen offset:1024
    buffer_load_dwordx2 v[66:67], v2, s[24:27], s74 offen offset:1536
K2_S0_MB_ISSUED:
    s_add_u32 s91, s91, 64
    s_sub_u32 s89, s89, s82
    s_cmp_lg_u32 s89, 0
    s_cbranch_scc1 K2_S0_MB_DONE
    s_mov_b32 s83, 1
    v_mov_b32 v122, 4288
    v_mov_b32 v123, 1
    s_mov_b64 exec, 1
    ds_add_rtn_u32 v123, v122, v123 offset:4
    s_waitcnt lgkmcnt(0)
    s_mov_b64 exec, -1
    v_readfirstlane_b32 s88, v123
    s_cmp_ge_u32 s88, 40
    s_cbranch_scc1 K2_S0_MB_DONE
    s_nop 3
    v_readlane_b32 s88, v124, s88
    s_lshl_b32 s67, s88, 2
    v_mov_b32 v122, s67
    ds_read_b32 v123, v122 offset:4096
    s_lshl_b32 s91, s88, 10
    s_add_u32 s91, s91, 11264
    v_and_b32 v122, 31, v1
    v_lshlrev_b32 v122, 5, v122
    v_add_u32 v122, s91, v122
    ds_read_b32 v3, v122
    s_mov_b32 s90, 0
    s_waitcnt lgkmcnt(0)
    v_readfirstlane_b32 s89, v123
K2_S0_MB_DONE:
    s_mov_b32 s92, s69
    s_cmp_eq_u32 s69, 0
    s_cbranch_scc1 K2_S0_NOFIN
    s_lshl_b32 s67, s72, 11
    v_add_u32 v118, s67, v2
    ds_read_b64 v[110:111], v118 offset:52224
    ds_read_b64 v[112:113], v118 offset:52736
    ds_read_b64 v[114:115], v118 offset:53248
    ds_read_b64 v[116:117], v118 offset:53760
    s_add_u32 s67, s66, s72
    s_lshl_b32 s75, s67, 11
    s_waitcnt lgkmcnt(0)
    v_lshlrev_b32 v118, 16, v110
    v_and_b32 v119, s78, v110
    v_lshlrev_b32 v120, 16, v111
    v_and_b32 v121, s78, v111
    v_add_f32 v118, v118, v28
    v_add_f32 v119, v119, v29
    v_add_f32 v120, v120, v30
    v_add_f32 v121, v121, v31
    v_cvt_pk_bf16_f32 v102, v118, v119
    v_cvt_pk_bf16_f32 v103, v120, v121
    buffer_store_dwordx2 v[102:103], v2, s[32:35], s75 offen offset:0 nt
    v_lshlrev_b32 v118, 16, v112
    v_and_b32 v119, s78, v112
    v_lshlrev_b32 v120, 16, v113
    v_and_b32 v121, s78, v113
    v_add_f32 v118, v118, v32
    v_add_f32 v119, v119, v33
    v_add_f32 v120, v120, v34
    v_add_f32 v121, v121, v35
    v_cvt_pk_bf16_f32 v104, v118, v119
    v_cvt_pk_bf16_f32 v105, v120, v121
    buffer_store_dwordx2 v[104:105], v2, s[32:35], s75 offen offset:512 nt
    v_lshlrev_b32 v118, 16, v114
    v_and_b32 v119, s78, v114
    v_lshlrev_b32 v120, 16, v115
    v_and_b32 v121, s78, v115
    v_add_f32 v118, v118, v36
    v_add_f32 v119, v119, v37
    v_add_f32 v120, v120, v38
    v_add_f32 v121, v121, v39
    v_cvt_pk_bf16_f32 v106, v118, v119
    v_cvt_pk_bf16_f32 v107, v120, v121
    buffer_store_dwordx2 v[106:107], v2, s[32:35], s75 offen offset:1024 nt
    v_lshlrev_b32 v118, 16, v116
    v_and_b32 v119, s78, v116
    v_lshlrev_b32 v120, 16, v117
    v_and_b32 v121, s78, v117
    v_add_f32 v118, v118, v40
    v_add_f32 v119, v119, v41
    v_add_f32 v120, v120, v42
    v_add_f32 v121, v121, v43
    v_cvt_pk_bf16_f32 v108, v118, v119
    v_cvt_pk_bf16_f32 v109, v120, v121
    buffer_store_dwordx2 v[108:109], v2, s[32:35], s75 offen offset:1536 nt
    v_mov_b32 v28, 0
    v_mov_b32 v29, 0
    v_mov_b32 v30, 0
    v_mov_b32 v31, 0
    v_mov_b32 v32, 0
    v_mov_b32 v33, 0
    v_mov_b32 v34, 0
    v_mov_b32 v35, 0
    v_mov_b32 v36, 0
    v_mov_b32 v37, 0
    v_mov_b32 v38, 0
    v_mov_b32 v39, 0
    v_mov_b32 v40, 0
    v_mov_b32 v41, 0
    v_mov_b32 v42, 0
    v_mov_b32 v43, 0
K2_S0_NOFIN:
    s_cmp_ge_u32 s84, 40
    s_cbranch_scc1 K2_END
    s_cmp_eq_u32 s86, 0
    s_cbranch_scc1 K2_S1_C0
    v_and_b32 v122, 3, v1
    v_lshlrev_b32 v122, 5, v122
    v_add_u32 v122, s85, v122
    ds_read_b64 v[92:93], v122 offset:8
    v_mov_b32 v123, s85
    ds_read_b128 v[94:97], v123 offset:16
    ds_read_b128 v[98:101], v123 offset:48
    s_mul_i32 s67, s82, 6
    s_lshl_b32 s68, s92, 2
    s_add_u32 s67, s67, s68
    s_cmp_eq_u32 s67, 16
    s_cbranch_scc1 K2_S1_W16
    s_cmp_eq_u32 s67, 12
    s_cbranch_scc1 K2_S1_W12
    s_cmp_eq_u32 s67, 10
    s_cbranch_scc1 K2_S1_W10
    s_cmp_eq_u32 s67, 6
    s_cbranch_scc1 K2_S1_W6
    s_cmp_eq_u32 s67, 4
    s_cbranch_scc1 K2_S1_W4
    s_waitcnt vmcnt(0)
    s_branch K2_S1_WD
K2_S1_W16:
    s_waitcnt vmcnt(16)
    s_branch K2_S1_WD
K2_S1_W12:
    s_waitcnt vmcnt(12)
    s_branch K2_S1_WD
K2_S1_W10:
    s_waitcnt vmcnt(10)
    s_branch K2_S1_WD
K2_S1_W6:
    s_waitcnt vmcnt(6)
    s_branch K2_S1_WD
K2_S1_W4:
    s_waitcnt vmcnt(4)
K2_S1_WD:
    s_waitcnt lgkmcnt(0)
    s_cmp_eq_u32 s86, 1
    s_cbranch_scc1 K2_S1_C1
    v_mfma_f32_4x4x4_16b_bf16 v[102:105], v[92:93], v[4:5], 0
    v_mfma_f32_4x4x4_16b_bf16 v[106:109], v[92:93], v[6:7], 0
    v_mfma_f32_4x4x4_16b_bf16 v[110:113], v[92:93], v[8:9], 0
    v_mfma_f32_4x4x4_16b_bf16 v[114:117], v[92:93], v[10:11], 0
    v_lshlrev_b32 v118, 16, v68
    v_and_b32 v119, s78, v68
    v_lshlrev_b32 v120, 16, v69
    v_and_b32 v121, s78, v69
    s_nop 1
    v_mul_f32 v118, v102, v118
    v_mul_f32 v119, v106, v119
    v_mul_f32 v120, v110, v120
    v_mul_f32 v121, v114, v121
    v_fma_f32 v28, v118, v94, v28
    v_fma_f32 v29, v119, v94, v29
    v_fma_f32 v30, v120, v94, v30
    v_fma_f32 v31, v121, v94, v31
    v_lshlrev_b32 v118, 16, v80
    v_and_b32 v119, s78, v80
    v_lshlrev_b32 v120, 16, v81
    v_and_b32 v121, s78, v81
    v_mul_f32 v118, v103, v118
    v_mul_f32 v119, v107, v119
    v_mul_f32 v120, v111, v120
    v_mul_f32 v121, v115, v121
    v_fma_f32 v28, v118, v98, v28
    v_fma_f32 v29, v119, v98, v29
    v_fma_f32 v30, v120, v98, v30
    v_fma_f32 v31, v121, v98, v31
    v_mfma_f32_4x4x4_16b_bf16 v[102:105], v[92:93], v[12:13], 0
    v_mfma_f32_4x4x4_16b_bf16 v[106:109], v[92:93], v[14:15], 0
    v_mfma_f32_4x4x4_16b_bf16 v[110:113], v[92:93], v[16:17], 0
    v_mfma_f32_4x4x4_16b_bf16 v[114:117], v[92:93], v[18:19], 0
    v_lshlrev_b32 v118, 16, v70
    v_and_b32 v119, s78, v70
    v_lshlrev_b32 v120, 16, v71
    v_and_b32 v121, s78, v71
    s_nop 1
    v_mul_f32 v118, v102, v118
    v_mul_f32 v119, v106, v119
    v_mul_f32 v120, v110, v120
    v_mul_f32 v121, v114, v121
    v_mul_f32 v102, v118, v94
    v_mul_f32 v106, v119, v94
    v_mul_f32 v110, v120, v94
    v_mul_f32 v114, v121, v94
    v_lshlrev_b32 v118, 16, v74
    v_and_b32 v119, s78, v74
    v_lshlrev_b32 v120, 16, v75
    v_and_b32 v121, s78, v75
    v_fma_f32 v32, v102, v118, v32
    v_fma_f32 v33, v106, v119, v33
    v_fma_f32 v34, v110, v120, v34
    v_fma_f32 v35, v114, v121, v35
    v_lshlrev_b32 v118, 16, v76
    v_and_b32 v119, s78, v76
    v_lshlrev_b32 v120, 16, v77
    v_and_b32 v121, s78, v77
    v_fma_f32 v36, v102, v118, v36
    v_fma_f32 v37, v106, v119, v37
    v_fma_f32 v38, v110, v120, v38
    v_fma_f32 v39, v114, v121, v39
    v_lshlrev_b32 v118, 16, v78
    v_and_b32 v119, s78, v78
    v_lshlrev_b32 v120, 16, v79
    v_and_b32 v121, s78, v79
    v_fma_f32 v40, v102, v118, v40
    v_fma_f32 v41, v106, v119, v41
    v_fma_f32 v42, v110, v120, v42
    v_fma_f32 v43, v114, v121, v43
    v_lshlrev_b32 v118, 16, v82
    v_and_b32 v119, s78, v82
    v_lshlrev_b32 v120, 16, v83
    v_and_b32 v121, s78, v83
    v_mul_f32 v118, v103, v118
    v_mul_f32 v119, v107, v119
    v_mul_f32 v120, v111, v120
    v_mul_f32 v121, v115, v121
    v_mul_f32 v103, v118, v98
    v_mul_f32 v107, v119, v98
    v_mul_f32 v111, v120, v98
    v_mul_f32 v115, v121, v98
    v_lshlrev_b32 v118, 16, v86
    v_and_b32 v119, s78, v86
    v_lshlrev_b32 v120, 16, v87
    v_and_b32 v121, s78, v87
    v_fma_f32 v32, v103, v118, v32
    v_fma_f32 v33, v107, v119, v33
    v_fma_f32 v34, v111, v120, v34
    v_fma_f32 v35, v115, v121, v35
    v_lshlrev_b32 v118, 16, v88
    v_and_b32 v119, s78, v88
    v_lshlrev_b32 v120, 16, v89
    v_and_b32 v121, s78, v89
    v_fma_f32 v36, v103, v118, v36
    v_fma_f32 v37, v107, v119, v37
    v_fma_f32 v38, v111, v120, v38
    v_fma_f32 v39, v115, v121, v39
    v_lshlrev_b32 v118, 16, v90
    v_and_b32 v119, s78, v90
    v_lshlrev_b32 v120, 16, v91
    v_and_b32 v121, s78, v91
    v_fma_f32 v40, v103, v118, v40
    v_fma_f32 v41, v107, v119, v41
    v_fma_f32 v42, v111, v120, v42
    v_fma_f32 v43, v115, v121, v43
    v_mfma_f32_4x4x4_16b_bf16 v[102:105], v[92:93], v[20:21], 0
    v_mfma_f32_4x4x4_16b_bf16 v[106:109], v[92:93], v[22:23], 0
    v_mfma_f32_4x4x4_16b_bf16 v[110:113], v[92:93], v[24:25], 0
    v_mfma_f32_4x4x4_16b_bf16 v[114:117], v[92:93], v[26:27], 0
    v_lshlrev_b32 v118, 16, v72
    v_and_b32 v119, s78, v72
    v_lshlrev_b32 v120, 16, v73
    v_and_b32 v121, s78, v73
    s_nop 1
    v_mul_f32 v118, v102, v118
    v_mul_f32 v119, v106, v119
    v_mul_f32 v120, v110, v120
    v_mul_f32 v121, v114, v121
    v_fma_f32 v32, v118, v95, v32
    v_fma_f32 v33, v119, v95, v33
    v_fma_f32 v34, v120, v95, v34
    v_fma_f32 v35, v121, v95, v35
    v_fma_f32 v36, v118, v96, v36
    v_fma_f32 v37, v119, v96, v37
    v_fma_f32 v38, v120, v96, v38
    v_fma_f32 v39, v121, v96, v39
    v_fma_f32 v40, v118, v97, v40
    v_fma_f32 v41, v119, v97, v41
    v_fma_f32 v42, v120, v97, v42
    v_fma_f32 v43, v121, v97, v43
    v_lshlrev_b32 v118, 16, v84
    v_and_b32 v119, s78, v84
    v_lshlrev_b32 v120, 16, v85
    v_and_b32 v121, s78, v85
    v_mul_f32 v118, v103, v118
    v_mul_f32 v119, v107, v119
    v_mul_f32 v120, v111, v120
    v_mul_f32 v121, v115, v121
    v_fma_f32 v32, v118, v99, v32
    v_fma_f32 v33, v119, v99, v33
    v_fma_f32 v34, v120, v99, v34
    v_fma_f32 v35, v121, v99, v35
    v_fma_f32 v36, v118, v100, v36
    v_fma_f32 v37, v119, v100, v37
    v_fma_f32 v38, v120, v100, v38
    v_fma_f32 v39, v121, v100, v39
    v_fma_f32 v40, v118, v101, v40
    v_fma_f32 v41, v119, v101, v41
    v_fma_f32 v42, v120, v101, v42
    v_fma_f32 v43, v121, v101, v43
    s_branch K2_S1_C0
K2_S1_C1:
    v_mfma_f32_4x4x4_16b_bf16 v[102:105], v[92:93], v[4:5], 0
    v_mfma_f32_4x4x4_16b_bf16 v[106:109], v[92:93], v[6:7], 0
    v_mfma_f32_4x4x4_16b_bf16 v[110:113], v[92:93], v[8:9], 0
    v_mfma_f32_4x4x4_16b_bf16 v[114:117], v[92:93], v[10:11], 0
    v_lshlrev_b32 v118, 16, v68
    v_and_b32 v119, s78, v68
    v_lshlrev_b32 v120, 16, v69
    v_and_b32 v121, s78, v69
    s_nop 1
    v_mul_f32 v118, v102, v118
    v_mul_f32 v119, v106, v119
    v_mul_f32 v120, v110, v120
    v_mul_f32 v121, v114, v121
    v_fma_f32 v28, v118, v94, v28
    v_fma_f32 v29, v119, v94, v29
    v_fma_f32 v30, v120, v94, v30
    v_fma_f32 v31, v121, v94, v31
    v_mfma_f32_4x4x4_16b_bf16 v[102:105], v[92:93], v[12:13], 0
    v_mfma_f32_4x4x4_16b_bf16 v[106:109], v[92:93], v[14:15], 0
    v_mfma_f32_4x4x4_16b_bf16 v[110:113], v[92:93], v[16:17], 0
    v_mfma_f32_4x4x4_16b_bf16 v[114:117], v[92:93], v[18:19], 0
    v_lshlrev_b32 v118, 16, v70
    v_and_b32 v119, s78, v70
    v_lshlrev_b32 v120, 16, v71
    v_and_b32 v121, s78, v71
    s_nop 1
    v_mul_f32 v118, v102, v118
    v_mul_f32 v119, v106, v119
    v_mul_f32 v120, v110, v120
    v_mul_f32 v121, v114, v121
    v_mul_f32 v102, v118, v94
    v_mul_f32 v106, v119, v94
    v_mul_f32 v110, v120, v94
    v_mul_f32 v114, v121, v94
    v_lshlrev_b32 v118, 16, v74
    v_and_b32 v119, s78, v74
    v_lshlrev_b32 v120, 16, v75
    v_and_b32 v121, s78, v75
    v_fma_f32 v32, v102, v118, v32
    v_fma_f32 v33, v106, v119, v33
    v_fma_f32 v34, v110, v120, v34
    v_fma_f32 v35, v114, v121, v35
    v_lshlrev_b32 v118, 16, v76
    v_and_b32 v119, s78, v76
    v_lshlrev_b32 v120, 16, v77
    v_and_b32 v121, s78, v77
    v_fma_f32 v36, v102, v118, v36
    v_fma_f32 v37, v106, v119, v37
    v_fma_f32 v38, v110, v120, v38
    v_fma_f32 v39, v114, v121, v39
    v_lshlrev_b32 v118, 16, v78
    v_and_b32 v119, s78, v78
    v_lshlrev_b32 v120, 16, v79
    v_and_b32 v121, s78, v79
    v_fma_f32 v40, v102, v118, v40
    v_fma_f32 v41, v106, v119, v41
    v_fma_f32 v42, v110, v120, v42
    v_fma_f32 v43, v114, v121, v43
    v_mfma_f32_4x4x4_16b_bf16 v[102:105], v[92:93], v[20:21], 0
    v_mfma_f32_4x4x4_16b_bf16 v[106:109], v[92:93], v[22:23], 0
    v_mfma_f32_4x4x4_16b_bf16 v[110:113], v[92:93], v[24:25], 0
    v_mfma_f32_4x4x4_16b_bf16 v[114:117], v[92:93], v[26:27], 0
    v_lshlrev_b32 v118, 16, v72
    v_and_b32 v119, s78, v72
    v_lshlrev_b32 v120, 16, v73
    v_and_b32 v121, s78, v73
    s_nop 1
    v_mul_f32 v118, v102, v118
    v_mul_f32 v119, v106, v119
    v_mul_f32 v120, v110, v120
    v_mul_f32 v121, v114, v121
    v_fma_f32 v32, v118, v95, v32
    v_fma_f32 v33, v119, v95, v33
    v_fma_f32 v34, v120, v95, v34
    v_fma_f32 v35, v121, v95, v35
    v_fma_f32 v36, v118, v96, v36
    v_fma_f32 v37, v119, v96, v37
    v_fma_f32 v38, v120, v96, v38
    v_fma_f32 v39, v121, v96, v39
    v_fma_f32 v40, v118, v97, v40
    v_fma_f32 v41, v119, v97, v41
    v_fma_f32 v42, v120, v97, v42
    v_fma_f32 v43, v121, v97, v43
K2_S1_C0:
    s_mov_b32 s69, s87
    s_mov_b32 s72, s84
    s_mov_b32 s84, s88
    s_mov_b32 s86, 0
    s_mov_b32 s87, 0
    s_cmp_ge_u32 s88, 40
    s_cbranch_scc1 K2_S1_MB_DONE
    s_mov_b32 s85, s91
    s_min_u32 s86, s89, 2
    s_cmp_le_u32 s86, 0
    s_cbranch_scc1 K2_S1_MB_ISSUED
    v_readlane_b32 s67, v3, s90
    s_add_u32 s90, s90, 1
    s_mul_i32 s73, s67, 1536
    s_lshl_b32 s74, s67, 11
    buffer_load_dwordx2 v[68:69], v2, s[28:31], s73 offen offset:0
    buffer_load_dwordx2 v[70:71], v2, s[28:31], s73 offen offset:512
    buffer_load_dwordx2 v[72:73], v2, s[28:31], s73 offen offset:1024
    buffer_load_dwordx2 v[74:75], v2, s[24:27], s74 offen offset:512
    buffer_load_dwordx2 v[76:77], v2, s[24:27], s74 offen offset:1024
    buffer_load_dwordx2 v[78:79], v2, s[24:27], s74 offen offset:1536
    s_cmp_le_u32 s86, 1
    s_cbranch_scc1 K2_S1_MB_ISSUED
    v_readlane_b32 s67, v3, s90
    s_add_u32 s90, s90, 1
    s_mul_i32 s73, s67, 1536
    s_lshl_b32 s74, s67, 11
    buffer_load_dwordx2 v[80:81], v2, s[28:31], s73 offen offset:0
    buffer_load_dwordx2 v[82:83], v2, s[28:31], s73 offen offset:512
    buffer_load_dwordx2 v[84:85], v2, s[28:31], s73 offen offset:1024
    buffer_load_dwordx2 v[86:87], v2, s[24:27], s74 offen offset:512
    buffer_load_dwordx2 v[88:89], v2, s[24:27], s74 offen offset:1024
    buffer_load_dwordx2 v[90:91], v2, s[24:27], s74 offen offset:1536
K2_S1_MB_ISSUED:
    s_add_u32 s91, s91, 64
    s_sub_u32 s89, s89, s86
    s_cmp_lg_u32 s89, 0
    s_cbranch_scc1 K2_S1_MB_DONE
    s_mov_b32 s87, 1
    v_mov_b32 v122, 4288
    v_mov_b32 v123, 1
    s_mov_b64 exec, 1
    ds_add_rtn_u32 v123, v122, v123 offset:4
    s_waitcnt lgkmcnt(0)
    s_mov_b64 exec, -1
    v_readfirstlane_b32 s88, v123
    s_cmp_ge_u32 s88, 40
    s_cbranch_scc1 K2_S1_MB_DONE
    s_nop 3
    v_readlane_b32 s88, v124, s88
    s_lshl_b32 s67, s88, 2
    v_mov_b32 v122, s67
    ds_read_b32 v123, v122 offset:4096
    s_lshl_b32 s91, s88, 10
    s_add_u32 s91, s91, 11264
    v_and_b32 v122, 31, v1
    v_lshlrev_b32 v122, 5, v122
    v_add_u32 v122, s91, v122
    ds_read_b32 v3, v122
    s_mov_b32 s90, 0
    s_waitcnt lgkmcnt(0)
    v_readfirstlane_b32 s89, v123
K2_S1_MB_DONE:
    s_mov_b32 s92, s69
    s_cmp_eq_u32 s69, 0
    s_cbranch_scc1 K2_S1_NOFIN
    s_lshl_b32 s67, s72, 11
    v_add_u32 v118, s67, v2
    ds_read_b64 v[110:111], v118 offset:52224
    ds_read_b64 v[112:113], v118 offset:52736
    ds_read_b64 v[114:115], v118 offset:53248
    ds_read_b64 v[116:117], v118 offset:53760
    s_add_u32 s67, s66, s72
    s_lshl_b32 s75, s67, 11
    s_waitcnt lgkmcnt(0)
    v_lshlrev_b32 v118, 16, v110
    v_and_b32 v119, s78, v110
    v_lshlrev_b32 v120, 16, v111
    v_and_b32 v121, s78, v111
    v_add_f32 v118, v118, v28
    v_add_f32 v119, v119, v29
    v_add_f32 v120, v120, v30
    v_add_f32 v121, v121, v31
    v_cvt_pk_bf16_f32 v102, v118, v119
    v_cvt_pk_bf16_f32 v103, v120, v121
    buffer_store_dwordx2 v[102:103], v2, s[32:35], s75 offen offset:0 nt
    v_lshlrev_b32 v118, 16, v112
    v_and_b32 v119, s78, v112
    v_lshlrev_b32 v120, 16, v113
    v_and_b32 v121, s78, v113
    v_add_f32 v118, v118, v32
    v_add_f32 v119, v119, v33
    v_add_f32 v120, v120, v34
    v_add_f32 v121, v121, v35
    v_cvt_pk_bf16_f32 v104, v118, v119
    v_cvt_pk_bf16_f32 v105, v120, v121
    buffer_store_dwordx2 v[104:105], v2, s[32:35], s75 offen offset:512 nt
    v_lshlrev_b32 v118, 16, v114
    v_and_b32 v119, s78, v114
    v_lshlrev_b32 v120, 16, v115
    v_and_b32 v121, s78, v115
    v_add_f32 v118, v118, v36
    v_add_f32 v119, v119, v37
    v_add_f32 v120, v120, v38
    v_add_f32 v121, v121, v39
    v_cvt_pk_bf16_f32 v106, v118, v119
    v_cvt_pk_bf16_f32 v107, v120, v121
    buffer_store_dwordx2 v[106:107], v2, s[32:35], s75 offen offset:1024 nt
    v_lshlrev_b32 v118, 16, v116
    v_and_b32 v119, s78, v116
    v_lshlrev_b32 v120, 16, v117
    v_and_b32 v121, s78, v117
    v_add_f32 v118, v118, v40
    v_add_f32 v119, v119, v41
    v_add_f32 v120, v120, v42
    v_add_f32 v121, v121, v43
    v_cvt_pk_bf16_f32 v108, v118, v119
    v_cvt_pk_bf16_f32 v109, v120, v121
    buffer_store_dwordx2 v[108:109], v2, s[32:35], s75 offen offset:1536 nt
    v_mov_b32 v28, 0
    v_mov_b32 v29, 0
    v_mov_b32 v30, 0
    v_mov_b32 v31, 0
    v_mov_b32 v32, 0
    v_mov_b32 v33, 0
    v_mov_b32 v34, 0
    v_mov_b32 v35, 0
    v_mov_b32 v36, 0
    v_mov_b32 v37, 0
    v_mov_b32 v38, 0
    v_mov_b32 v39, 0
    v_mov_b32 v40, 0
    v_mov_b32 v41, 0
    v_mov_b32 v42, 0
    v_mov_b32 v43, 0
K2_S1_NOFIN:
    s_branch K2_LOOP
K2_SLOW0:
    s_waitcnt vmcnt(0)
    v_lshlrev_b32 v122, 4, v0
    v_add_u32 v123, 117760, v122
    v_add_u32 v122, 52224, v122
    ds_write_b128 v122, v[102:105] offset:0
    ds_write_b128 v122, v[106:109] offset:16384
    ds_write_b128 v122, v[110:113] offset:32768
    ds_write_b128 v122, v[114:117] offset:49152
    ds_write_b128 v123, v[118:121]
    s_waitcnt lgkmcnt(0)
    s_barrier
    s_mov_b32 s72, s64
K2_SNODE:
    s_add_u32 s70, s66, s72
    v_mov_b32 v28, 0
    v_mov_b32 v29, 0
    v_mov_b32 v30, 0
    v_mov_b32 v31, 0
    v_mov_b32 v32, 0
    v_mov_b32 v33, 0
    v_mov_b32 v34, 0
    v_mov_b32 v35, 0
    v_mov_b32 v36, 0
    v_mov_b32 v37, 0
    v_mov_b32 v38, 0
    v_mov_b32 v39, 0
    v_mov_b32 v40, 0
    v_mov_b32 v41, 0
    v_mov_b32 v42, 0
    v_mov_b32 v43, 0
    s_mov_b32 s93, 0
K2_SSEG:
    s_lshl_b32 s94, s93, 2
    v_mov_b32 v3, s94
    buffer_load_dword v110, v3, s[44:47], 0 offen
    s_waitcnt vmcnt(0)
    v_readfirstlane_b32 s95, v110
    s_mov_b32 s79, 0
K2_SCHUNK:
    s_cmp_ge_u32 s79, s95
    s_cbranch_scc1 K2_SSEGEND
    s_mul_i32 s62, s93, 640
    s_add_u32 s62, s62, s79
    v_add_u32 v110, s62, v1
    v_lshlrev_b32 v110, 5, v110
    buffer_load_dword v111, v110, s[36:39], 0 offen offset:4
    v_add_u32 v112, s79, v1
    s_waitcnt vmcnt(0)
    v_cmp_eq_u32 vcc, s70, v111
    v_cmp_gt_u32 s[60:61], s95, v112
    s_nop 1
    s_and_b64 s[60:61], s[60:61], vcc
K2_SEDGE:
    s_cmp_eq_u64 s[60:61], 0
    s_cbranch_scc1 K2_SCHUNKEND
    s_ff1_i32_b64 s63, s[60:61]
    s_bitset0_b64 s[60:61], s63
    s_add_u32 s63, s63, s62
    s_lshl_b32 s63, s63, 5
    v_mov_b32 v110, s63
    buffer_load_dword v111, v110, s[36:39], 0 offen
    buffer_load_dwordx2 v[92:93], v110, s[36:39], 0 offen offset:8
    buffer_load_dwordx4 v[94:97], v110, s[36:39], 0 offen offset:16
    s_waitcnt vmcnt(0)
    v_readfirstlane_b32 s67, v111
    s_mul_i32 s73, s67, 1536
    s_lshl_b32 s74, s67, 11
    buffer_load_dwordx2 v[44:45], v2, s[28:31], s73 offen offset:0
    buffer_load_dwordx2 v[46:47], v2, s[28:31], s73 offen offset:512
    buffer_load_dwordx2 v[48:49], v2, s[28:31], s73 offen offset:1024
    buffer_load_dwordx2 v[50:51], v2, s[24:27], s74 offen offset:512
    buffer_load_dwordx2 v[52:53], v2, s[24:27], s74 offen offset:1024
    buffer_load_dwordx2 v[54:55], v2, s[24:27], s74 offen offset:1536
    s_waitcnt vmcnt(0)
    v_mfma_f32_4x4x4_16b_bf16 v[102:105], v[92:93], v[4:5], 0
    v_mfma_f32_4x4x4_16b_bf16 v[106:109], v[92:93], v[6:7], 0
    v_mfma_f32_4x4x4_16b_bf16 v[110:113], v[92:93], v[8:9], 0
    v_mfma_f32_4x4x4_16b_bf16 v[114:117], v[92:93], v[10:11], 0
    v_lshlrev_b32 v118, 16, v44
    v_and_b32 v119, s78, v44
    v_lshlrev_b32 v120, 16, v45
    v_and_b32 v121, s78, v45
    s_nop 1
    v_mul_f32 v118, v102, v118
    v_mul_f32 v119, v106, v119
    v_mul_f32 v120, v110, v120
    v_mul_f32 v121, v114, v121
    v_fma_f32 v28, v118, v94, v28
    v_fma_f32 v29, v119, v94, v29
    v_fma_f32 v30, v120, v94, v30
    v_fma_f32 v31, v121, v94, v31
    v_mfma_f32_4x4x4_16b_bf16 v[102:105], v[92:93], v[12:13], 0
    v_mfma_f32_4x4x4_16b_bf16 v[106:109], v[92:93], v[14:15], 0
    v_mfma_f32_4x4x4_16b_bf16 v[110:113], v[92:93], v[16:17], 0
    v_mfma_f32_4x4x4_16b_bf16 v[114:117], v[92:93], v[18:19], 0
    v_lshlrev_b32 v118, 16, v46
    v_and_b32 v119, s78, v46
    v_lshlrev_b32 v120, 16, v47
    v_and_b32 v121, s78, v47
    s_nop 1
    v_mul_f32 v118, v102, v118
    v_mul_f32 v119, v106, v119
    v_mul_f32 v120, v110, v120
    v_mul_f32 v121, v114, v121
    v_mul_f32 v102, v118, v94
    v_mul_f32 v106, v119, v94
    v_mul_f32 v110, v120, v94
    v_mul_f32 v114, v121, v94
    v_lshlrev_b32 v118, 16, v50
    v_and_b32 v119, s78, v50
    v_lshlrev_b32 v120, 16, v51
    v_and_b32 v121, s78, v51
    v_fma_f32 v32, v102, v118, v32
    v_fma_f32 v33, v106, v119, v33
    v_fma_f32 v34, v110, v120, v34
    v_fma_f32 v35, v114, v121, v35
    v_lshlrev_b32 v118, 16, v52
    v_and_b32 v119, s78, v52
    v_lshlrev_b32 v120, 16, v53
    v_and_b32 v121, s78, v53
    v_fma_f32 v36, v102, v118, v36
    v_fma_f32 v37, v106, v119, v37
    v_fma_f32 v38, v110, v120, v38
    v_fma_f32 v39, v114, v121, v39
    v_lshlrev_b32 v118, 16, v54
    v_and_b32 v119, s78, v54
    v_lshlrev_b32 v120, 16, v55
    v_and_b32 v121, s78, v55
    v_fma_f32 v40, v102, v118, v40
    v_fma_f32 v41, v106, v119, v41
    v_fma_f32 v42, v110, v120, v42
    v_fma_f32 v43, v114, v121, v43
    v_mfma_f32_4x4x4_16b_bf16 v[102:105], v[92:93], v[20:21], 0
    v_mfma_f32_4x4x4_16b_bf16 v[106:109], v[92:93], v[22:23], 0
    v_mfma_f32_4x4x4_16b_bf16 v[110:113], v[92:93], v[24:25], 0
    v_mfma_f32_4x4x4_16b_bf16 v[114:117], v[92:93], v[26:27], 0
    v_lshlrev_b32 v118, 16, v48
    v_and_b32 v119, s78, v48
    v_lshlrev_b32 v120, 16, v49
    v_and_b32 v121, s78, v49
    s_nop 1
    v_mul_f32 v118, v102, v118
    v_mul_f32 v119, v106, v119
    v_mul_f32 v120, v110, v120
    v_mul_f32 v121, v114, v121
    v_fma_f32 v32, v118, v95, v32
    v_fma_f32 v33, v119, v95, v33
    v_fma_f32 v34, v120, v95, v34
    v_fma_f32 v35, v121, v95, v35
    v_fma_f32 v36, v118, v96, v36
    v_fma_f32 v37, v119, v96, v37
    v_fma_f32 v38, v120, v96, v38
    v_fma_f32 v39, v121, v96, v39
    v_fma_f32 v40, v118, v97, v40
    v_fma_f32 v41, v119, v97, v41
    v_fma_f32 v42, v120, v97, v42
    v_fma_f32 v43, v121, v97, v43
    s_branch K2_SEDGE
K2_SCHUNKEND:
    s_add_u32 s79, s79, 64
    s_branch K2_SCHUNK
K2_SSEGEND:
    s_add_u32 s93, s93, 1
    s_cmp_lt_u32 s93, 250
    s_cbranch_scc1 K2_SSEG
    s_lshl_b32 s67, s72, 11
    v_add_u32 v118, s67, v2
    ds_read_b64 v[110:111], v118 offset:52224
    ds_read_b64 v[112:113], v118 offset:52736
    ds_read_b64 v[114:115], v118 offset:53248
    ds_read_b64 v[116:117], v118 offset:53760
    s_add_u32 s67, s66, s72
    s_lshl_b32 s75, s67, 11
    s_waitcnt lgkmcnt(0)
    v_lshlrev_b32 v118, 16, v110
    v_and_b32 v119, s78, v110
    v_lshlrev_b32 v120, 16, v111
    v_and_b32 v121, s78, v111
    v_add_f32 v118, v118, v28
    v_add_f32 v119, v119, v29
    v_add_f32 v120, v120, v30
    v_add_f32 v121, v121, v31
    v_cvt_pk_bf16_f32 v102, v118, v119
    v_cvt_pk_bf16_f32 v103, v120, v121
    buffer_store_dwordx2 v[102:103], v2, s[32:35], s75 offen offset:0 nt
    v_lshlrev_b32 v118, 16, v112
    v_and_b32 v119, s78, v112
    v_lshlrev_b32 v120, 16, v113
    v_and_b32 v121, s78, v113
    v_add_f32 v118, v118, v32
    v_add_f32 v119, v119, v33
    v_add_f32 v120, v120, v34
    v_add_f32 v121, v121, v35
    v_cvt_pk_bf16_f32 v104, v118, v119
    v_cvt_pk_bf16_f32 v105, v120, v121
    buffer_store_dwordx2 v[104:105], v2, s[32:35], s75 offen offset:512 nt
    v_lshlrev_b32 v118, 16, v114
    v_and_b32 v119, s78, v114
    v_lshlrev_b32 v120, 16, v115
    v_and_b32 v121, s78, v115
    v_add_f32 v118, v118, v36
    v_add_f32 v119, v119, v37
    v_add_f32 v120, v120, v38
    v_add_f32 v121, v121, v39
    v_cvt_pk_bf16_f32 v106, v118, v119
    v_cvt_pk_bf16_f32 v107, v120, v121
    buffer_store_dwordx2 v[106:107], v2, s[32:35], s75 offen offset:1024 nt
    v_lshlrev_b32 v118, 16, v116
    v_and_b32 v119, s78, v116
    v_lshlrev_b32 v120, 16, v117
    v_and_b32 v121, s78, v117
    v_add_f32 v118, v118, v40
    v_add_f32 v119, v119, v41
    v_add_f32 v120, v120, v42
    v_add_f32 v121, v121, v43
    v_cvt_pk_bf16_f32 v108, v118, v119
    v_cvt_pk_bf16_f32 v109, v120, v121
    buffer_store_dwordx2 v[108:109], v2, s[32:35], s75 offen offset:1536 nt
    v_mov_b32 v28, 0
    v_mov_b32 v29, 0
    v_mov_b32 v30, 0
    v_mov_b32 v31, 0
    v_mov_b32 v32, 0
    v_mov_b32 v33, 0
    v_mov_b32 v34, 0
    v_mov_b32 v35, 0
    v_mov_b32 v36, 0
    v_mov_b32 v37, 0
    v_mov_b32 v38, 0
    v_mov_b32 v39, 0
    v_mov_b32 v40, 0
    v_mov_b32 v41, 0
    v_mov_b32 v42, 0
    v_mov_b32 v43, 0
    s_add_u32 s72, s72, 16
    s_cmp_ge_u32 s72, 40
    s_cbranch_scc1 K2_END
    s_branch K2_SNODE
K2_END:
    s_endpgm
.section .rodata,"a"
.p2align 6
.amdhsa_kernel k_phi_kernel
  .amdhsa_next_free_vgpr 248
  .amdhsa_next_free_sgpr 102
  .amdhsa_accum_offset 208
  .amdhsa_group_segment_fixed_size 0
  .amdhsa_kernarg_size 88
  .amdhsa_user_sgpr_count 2
  .amdhsa_user_sgpr_kernarg_segment_ptr 1
  .amdhsa_system_sgpr_workgroup_id_x 1
.end_amdhsa_kernel
.p2align 6
.amdhsa_kernel k_edge_kernel
  .amdhsa_next_free_vgpr 128
  .amdhsa_next_free_sgpr 102
  .amdhsa_accum_offset 128
  .amdhsa_group_segment_fixed_size 0
  .amdhsa_kernarg_size 88
  .amdhsa_user_sgpr_count 2
  .amdhsa_user_sgpr_kernarg_segment_ptr 1
  .amdhsa_system_sgpr_workgroup_id_x 1
.end_amdhsa_kernel
```
